```python
import torch

def _softmax(x, axis=-1):
    return torch.softmax(x, dim=axis)

def _gelu(x):
    return torch.nn.functional.gelu(x, approximate='tanh')

def _silu(x):
    return torch.nn.functional.silu(x)

def _sigmoid(x):
    return torch.sigmoid(x)

def _layernorm(x, axis=-1, eps=1e-05):
    m = x.mean(dim=axis, keepdim=True)
    v = x.var(dim=axis, keepdim=True, unbiased=False)
    return (x - m) / torch.sqrt(v + eps)

def _scatter_add(tgt, idx, src, axis=0):
    return tgt.clone().index_add_(axis, idx, src)

def _segment_sum(src, seg, n):
    out = torch.zeros((n,) + src.shape[1:], dtype=src.dtype)
    return out.index_add_(0, seg, src)

def _pad(x, pw):
    flat = tuple((v for pair in reversed(pw) for v in pair))
    return torch.nn.functional.pad(x, flat)
kernel_name = 'adaLN_cond__ssm_conv_h3__mixer_channel_mlp__prompt'

def setup_inputs():

    _w = lambda a: (lambda t: t.to(torch.bfloat16) if t.is_floating_point() else t)(torch.as_tensor(a))

    def _A_setup():
        B, S, D = (1, 2048, 1024)
        ks = 4
        return {'q': _w((lambda *s: torch.randn(*s, dtype=torch.bfloat16) * 0.05)(B, S, D)), 'k': _w((lambda *s: torch.randn(*s, dtype=torch.bfloat16) * 0.4)(B, S, D)), 'v': _w((lambda *s: torch.randn(*s, dtype=torch.bfloat16) * 0.4)(B, S, D)), 'shift_k': _w((lambda *s: torch.randn(*s, dtype=torch.bfloat16) * 0.4)(D, ks) * 0.5), 'ssm_k': _w((lambda *s: torch.randn(*s, dtype=torch.bfloat16) * 0.4)(D, S) * (1.0 / S ** 0.5)), 'ssm_D': _w((lambda *s: torch.randn(*s, dtype=torch.bfloat16) * 0.4)(D))}
    _A_in = _A_setup()

    def _B_setup():
        B, S, D, F = (1, 2048, 1024, 3584)
        return {'x': _w((lambda *s: torch.randn(*s, dtype=torch.bfloat16) * 0.05)(B, S, D)), 'w1': _w((lambda *s: torch.randn(*s, dtype=torch.bfloat16) * 3.2)(D, F) * D ** (-0.5)), 'b1': _w((lambda *s: torch.randn(*s, dtype=torch.bfloat16) * 1.6)(F)), 'w2': _w((lambda *s: torch.randn(*s, dtype=torch.bfloat16) * 0.2)(F, D) * F ** (-0.5)), 'b2': _w((lambda *s: torch.randn(*s, dtype=torch.bfloat16) * 0.4)(D))}
    _B_in = _B_setup()
    return {'A_q': _A_in['q'], 'A_k': _A_in['k'], 'A_v': _A_in['v'], 'A_shift_k': _A_in['shift_k'], 'A_ssm_k': _A_in['ssm_k'], 'A_ssm_D': _A_in['ssm_D'], 'B_x': _B_in['x'], 'B_w1': _B_in['w1'], 'B_b1': _B_in['b1'], 'B_w2': _B_in['w2'], 'B_b2': _B_in['b2'], 'c': _w((lambda *s: torch.randn(*s, dtype=torch.bfloat16) * 0.2)(1, 1024) * 8.0), 'w_mod': _w((lambda *s: torch.randn(*s, dtype=torch.bfloat16) * 0.2)(1024, 6 * 1024) * 1024 ** (-0.5) * 8.0)}

def reference(A_q, A_k, A_v, A_shift_k, A_ssm_k, A_ssm_D, B_x, B_w1, B_b1, B_w2, B_b2, c, w_mod):

    def _A_ref(q, k, v, shift_k, ssm_k, ssm_D):
        B, S, D = q.shape
        ks = shift_k.shape[-1]
        k_pad = _pad(k, ((0, 0), (ks - 1, 0), (0, 0)))
        k_shift = torch.zeros_like(k)
        for t in range(ks):
            k_shift = k_shift + k_pad[:, t:t + S, :] * shift_k[:, ks - 1 - t][None, None, :]
        kv = k_shift * v
        L = 2 * S
        kv_pad = _pad(kv, ((0, 0), (0, S), (0, 0)))
        kf_pad = _pad(ssm_k, ((0, 0), (0, S)))
        kv_f = (lambda x, axes=(-2, -1): torch.fft.rfft2(x.float(), dim=axes))(kv_pad[:, None, :, :], axes=(1, 2))
        kf_f = (lambda x, axes=(-2, -1): torch.fft.rfft2(x.float(), dim=axes))(kf_pad[:, None, :], axes=(1, 2))
        kf_f = (lambda x, *d: x.permute(*d))(kf_f, 1, 2, 0)
        y_f = kv_f * kf_f[None, :, :, :]
        y = (lambda x, s, axes=(-2, -1): torch.fft.irfft2(x, s=s, dim=axes).to(torch.bfloat16))(y_f, (1, L), axes=(1, 2))[:, 0, :S, :]
        y = y + kv * ssm_D[None, None, :]
        return q * y

    def _B_ref(x, w1, b1, w2, b2):
        y = _layernorm(x, axis=-1)
        h = _gelu(torch.einsum('bsd,df->bsf', y, w1) + b1)
        return torch.einsum('bsf,fd->bsd', h, w2) + b2
    x = A_q
    mod = (_silu(c) @ w_mod).reshape(c.shape[0], 6, 1, -1)
    sa, ca, ga, sb, cb, gb = (mod[:, 0].clone(), mod[:, 1].clone(), mod[:, 2].clone(), mod[:, 3].clone(), mod[:, 4].clone(), mod[:, 5].clone())
    h = _layernorm(x, axis=-1) * (1 + ca) + sa
    x = x + ga * _A_ref(h, A_k, A_v, A_shift_k, A_ssm_k, A_ssm_D)
    h = _layernorm(x, axis=-1) * (1 + cb) + sb
    x = x + gb * _B_ref(h, B_w1, B_b1, B_w2, B_b2)
    return x
```

```asm
; @launch kernel=ka_kernel grid=(256,1,1) block=(512,1,1) lds=127104
; @launch kernel=km_kernel grid=(256,1,1) block=(512,1,1) lds=163840
.amdgcn_target "amdgcn-amd-amdhsa--gfx950"
.text
.globl ka_kernel
.p2align 8
.type ka_kernel,@function
ka_kernel:
    s_cmp_ge_u32 s2, 256
    s_cbranch_scc1 KA_end
    s_load_dwordx4 s[4:7], s[0:1], 8
    s_load_dwordx2 s[10:11], s[0:1], 120
    s_load_dwordx4 s[12:15], s[0:1], 24
    v_lshrrev_b32 v1, 6, v0
    v_and_b32 v2, 63, v0
    v_readfirstlane_b32 s3, v1
    s_and_b32 s44, s2, 7
    s_lshr_b32 s45, s2, 3
    s_lshl_b32 s43, s44, 5
    s_add_u32 s43, s43, s45
    s_lshr_b32 s44, s43, 4
    s_and_b32 s45, s45, 15
    s_lshl_b32 s46, s45, 7
    s_lshl_b32 s47, s3, 4
    s_add_u32 s46, s46, s47
    s_lshl_b32 s47, s46, 11
    s_lshl_b32 s48, s44, 7
    s_add_u32 s47, s47, s48
    v_lshrrev_b32 v7, 3, v2
    v_and_b32 v15, 7, v2
    v_lshlrev_b32 v3, 11, v7
    v_lshl_add_u32 v3, v15, 4, v3
    v_add_u32 v3, s47, v3
    v_add_u32 v4, 0xffffc000, v3
    s_mul_i32 s49, s3, 5120
    s_add_u32 s49, s49, 85120
    s_mov_b32 s50, 16384
    s_mov_b32 s18, 4194304
    s_mov_b32 s19, 0x20000
    s_mov_b32 s22, 4194304
    s_mov_b32 s23, 0x20000
    s_mov_b32 s26, 8192
    s_mov_b32 s27, 0x20000
    s_lshl_b32 s51, s44, 9
    v_lshl_add_u32 v5, v2, 3, s51
    s_add_u32 m0, s49, 1024
    s_waitcnt lgkmcnt(0)
    s_mov_b32 s16, s4
    s_mov_b32 s17, s5
    s_mov_b32 s20, s6
    s_mov_b32 s21, s7
    buffer_load_dwordx4 v3, s[16:19], 0 offen  lds
    s_add_u32 m0, s49, 3072
    s_mov_b32 s24, s12
    buffer_load_dwordx4 v3, s[20:23], 0 offen  lds
    s_add_u32 m0, s49, 2048
    s_mov_b32 s25, s13
    buffer_load_dwordx4 v3, s[16:19], s50 offen  lds
    s_add_u32 m0, s49, 4096
    buffer_load_dwordx2 v[8:9], v5, s[24:27], 0 offen
    buffer_load_dwordx4 v3, s[20:23], s50 offen  lds
    s_mov_b32 m0, s49
    s_mov_b32 exec_lo, 0
    buffer_load_dwordx4 v4, s[16:19], 0 offen  lds
    s_mov_b32 exec_lo, -1
    s_lshl_b32 s51, s44, 9
    s_add_u32 s52, s10, s51
    s_addc_u32 s53, s11, 0
    s_add_u32 s52, s52, 51380224
    s_addc_u32 s53, s53, 0
    s_load_dword s42, s[52:53], 256
    s_load_dwordx2 s[4:5], s[0:1], 40
    s_load_dwordx4 s[56:59], s[0:1], 88
    s_load_dwordx2 s[6:7], s[0:1], 0
    s_load_dwordx2 s[8:9], s[0:1], 56
    s_add_u32 s28, s10, 21028864
    s_addc_u32 s29, s11, 0
    s_mov_b32 s30, 14622720
    s_mov_b32 s31, 0x20000
    s_lshr_b32 s55, s44, 1
    s_mul_i32 s55, s55, 112
    s_and_b32 s63, s44, 1
    s_mul_i32 s63, s63, 28
    s_add_u32 s55, s55, s63
    s_lshl_b32 s55, s55, 10
    s_mul_i32 s63, s45, 917504
    s_add_u32 s55, s55, s63
    s_lshl_b32 s63, s3, 7
    s_add_u32 s55, s55, s63
    v_lshrrev_b32 v6, 4, v2
    v_and_b32 v50, 1, v6
    v_mad_u32_u24 v6, v6, 7, v50
    v_bfe_u32 v50, v2, 2, 2
    v_add_lshl_u32 v6, v6, v50, 10
    v_and_b32 v50, 3, v2
    v_lshl_add_u32 v6, v50, 4, v6
    v_add_u32 v6, s55, v6
    v_lshrrev_b32 v51, 5, v2
    v_lshlrev_b32 v51, 3, v51
    v_and_b32 v50, 3, v7
    v_add_lshl_u32 v51, v51, v50, 10
    v_lshl_add_u32 v51, v15, 4, v51
    v_add_u32 v51, s55, v51
    s_mov_b32 s40, 14336
    s_getreg_b32 s41, hwreg(HW_REG_XCC_ID, 0, 4)
    s_barrier
    buffer_load_dwordx4 v[164:167], v51, s[28:31], 0 offen sc1
    buffer_load_dwordx4 v[168:171], v51, s[28:31], s40 offen sc1
    s_cmp_ge_u32 s3, 4
    s_cbranch_scc1 KA_hpre
    s_mov_b32 s32, s14
    s_mov_b32 s33, s15
    s_mov_b32 s34, 4194304
    s_mov_b32 s35, 0x20000
    s_lshl_b32 s54, s43, 2
    s_add_u32 s54, s54, s3
    s_lshl_b32 s55, s54, 12
    v_lshl_add_u32 v5, v2, 4, s55
    s_waitcnt lgkmcnt(0)
    s_add_u32 s42, s42, 0x9e3779b9
    s_mov_b32 s36, s4
    s_mov_b32 s37, s5
    s_mov_b32 s38, 2048
    s_mov_b32 s39, 0x20000
    s_mov_b32 s24, s52
    s_mov_b32 s25, s53
    s_mov_b32 s26, 512
    s_mov_b32 s27, 0x20000
    s_lshl_b32 s55, s54, 1
    v_mov_b32 v50, s55
    v_mov_b32 v108, 0
    v_mov_b32 v78, -1
    v_mov_b32 v72, 0
    s_mov_b32 s64, s52
    s_mov_b32 s65, s53
    s_mov_b32 s66, 512
    s_mov_b32 s67, 0x20000
    v_and_b32 v22, 15, v2
    v_lshlrev_b32 v22, 2, v22
    v_and_b32 v23, 16, v2
    v_lshl_add_u32 v127, v23, 3, v22
    s_waitcnt vmcnt(2)
    buffer_load_dwordx4 v[128:131], v5, s[32:35], 0 offen offset:0
    buffer_load_dwordx2 v[132:133], v5, s[32:35], 0 offen offset:16
    buffer_load_dwordx4 v[134:137], v5, s[32:35], 0 offen offset:1024
    buffer_load_dwordx2 v[138:139], v5, s[32:35], 0 offen offset:1040
    buffer_load_dwordx4 v[140:143], v5, s[32:35], 0 offen offset:2048
    buffer_load_dwordx2 v[144:145], v5, s[32:35], 0 offen offset:2064
    buffer_load_dwordx4 v[146:149], v5, s[32:35], 0 offen offset:3072
    buffer_load_dwordx2 v[150:151], v5, s[32:35], 0 offen offset:3088
    buffer_load_ushort v126, v50, s[36:39], 0 offen
    buffer_load_dword v160, v127, s[24:27], 0 offen sc1
    s_branch KA_phaseA
KA_hpre:
    s_waitcnt lgkmcnt(0)
    s_mov_b32 s32, s56
    s_mov_b32 s33, s57
    s_mov_b32 s34, 2048
    s_mov_b32 s35, 0x20000
    s_mov_b32 s36, s58
    s_mov_b32 s37, s59
    s_mov_b32 s38, 12582912
    s_mov_b32 s39, 0x20000
    s_mov_b32 s64, s52
    s_mov_b32 s65, s53
    s_mov_b32 s66, 512
    s_mov_b32 s67, 0x20000
    s_add_u32 s42, s42, 0x9e3779b9
    s_lshl_b32 s58, s45, 2
    v_mov_b32 v72, s58
    s_add_u32 s58, s42, s41
    v_mov_b32 v73, s58
    v_mov_b32 v74, s42
    v_and_b32 v75, 15, v2
    v_lshlrev_b32 v75, 2, v75
    v_mov_b32 v127, 0
    s_sub_u32 s60, s3, 4
    s_and_b32 s61, s2, 7
    s_mul_i32 s61, s61, 12
    s_lshr_b32 s62, s2, 4
    s_add_u32 s61, s61, s62
    s_bfe_u32 s62, s2, 0x10003
    s_lshl_b32 s54, s62, 9
    s_lshl_b32 s55, s60, 7
    s_add_u32 s54, s54, s55
    v_lshl_add_u32 v60, v7, 4, s54
    v_lshlrev_b32 v61, 1, v60
    s_mov_b32 s55, 12288
    v_mul_lo_u32 v108, v60, s55
    s_lshl_b32 s55, s61, 7
    v_lshl_add_u32 v109, v15, 4, s55
    v_add_u32 v108, v108, v109
    s_mov_b32 s16, s10
    s_mov_b32 s17, s11
    s_mov_b32 s18, 0x4000000
    s_lshr_b32 s54, s61, 3
    s_lshl_b32 s54, s54, 11
    s_and_b32 s55, s61, 7
    s_lshl_b32 s55, s55, 7
    s_add_u32 s54, s54, s55
    s_add_u32 s54, s54, 4456448
    v_bfe_u32 v78, v2, 2, 1
    v_lshlrev_b32 v78, 10, v78
    v_lshl_add_u32 v78, v7, 4, v78
    v_and_b32 v79, 3, v2
    v_lshl_add_u32 v78, v79, 2, v78
    v_add_u32 v78, s54, v78
    v_mov_b32 v80, 0
    s_mul_i32 s54, s2, 432
    s_sub_u32 s55, s60, 1
    s_lshl_b32 s55, s55, 8
    s_add_u32 s54, s54, s55
    s_add_u32 s54, s54, 52428800
    v_lshl_add_u32 v79, v2, 2, s54
    s_lshl_b32 s55, s60, 6
    v_add_u32 v81, s55, v2
    v_cmp_gt_u32 vcc, 172, v81
    v_mov_b32 v81, 0x4000000
    s_cmp_lt_u32 s2, 192
    s_cselect_b32 s54, s62, 1
    v_cndmask_b32 v79, v81, v79, vcc
    s_cmp_lg_u32 s60, 0
    s_cbranch_scc1 KA_z1
    s_cmp_eq_u32 s54, 0
    s_cselect_b64 vcc, -1, 0
    v_cndmask_b32 v79, v81, v78, vcc
KA_z1:
    buffer_store_dword v80, v79, s[16:19], 0 offen sc1
    buffer_load_dwordx4 v[64:67], v61, s[32:35], 0 offen
    buffer_load_dwordx4 v[68:71], v61, s[32:35], 0 offen offset:16
    s_waitcnt vmcnt(5)
KA_phaseA:
    v_lshrrev_b32 v5, 4, v2
    v_bfe_u32 v10, v2, 2, 2
    v_and_b32 v11, 3, v2
    v_lshlrev_b32 v10, 7, v10
    v_lshl_add_u32 v10, v5, 5, v10
    v_lshl_add_u32 v10, v11, 3, v10
    v_add_u32 v5, s49, v10
    ds_read_b64_tr_b16 v[16:17], v5 offset:512
    ds_read_b64_tr_b16 v[18:19], v5 offset:1024
    ds_read_b64_tr_b16 v[20:21], v5 offset:1536
    ds_read_b64_tr_b16 v[22:23], v5 offset:2048
    ds_read_b64_tr_b16 v[24:25], v5 offset:2560
    ds_read_b64_tr_b16 v[26:27], v5 offset:3072
    ds_read_b64_tr_b16 v[28:29], v5 offset:3584
    ds_read_b64_tr_b16 v[30:31], v5 offset:4096
    ds_read_b64_tr_b16 v[32:33], v5 offset:4608
    v_alignbit_b32 v10, v8, v8, 16
    v_alignbit_b32 v11, v9, v9, 16
    v_and_b32 v12, 0xffff, v8
    s_mov_b32 s55, 0xffff
    v_bfi_b32 v13, s55, v9, v8
    v_and_b32 v14, 0xffff0000, v9
    s_waitcnt lgkmcnt(4)
    v_dot2_f32_bf16 v34, v18, v12, 0
    v_dot2_f32_bf16 v35, v18, v10, 0
    v_dot2_f32_bf16 v36, v19, v12, 0
    v_dot2_f32_bf16 v37, v19, v10, 0
    v_dot2_f32_bf16 v38, v20, v12, 0
    v_dot2_f32_bf16 v39, v20, v10, 0
    v_dot2_f32_bf16 v40, v21, v12, 0
    v_dot2_f32_bf16 v41, v21, v10, 0
    v_dot2_f32_bf16 v42, v22, v12, 0
    v_dot2_f32_bf16 v43, v22, v10, 0
    v_dot2_f32_bf16 v44, v23, v12, 0
    v_dot2_f32_bf16 v45, v23, v10, 0
    v_dot2_f32_bf16 v46, v24, v12, 0
    v_dot2_f32_bf16 v47, v24, v10, 0
    v_dot2_f32_bf16 v48, v25, v12, 0
    v_dot2_f32_bf16 v49, v25, v10, 0
    v_dot2_f32_bf16 v34, v17, v13, v34
    v_dot2_f32_bf16 v35, v17, v11, v35
    v_dot2_f32_bf16 v36, v18, v13, v36
    v_dot2_f32_bf16 v37, v18, v11, v37
    v_dot2_f32_bf16 v38, v19, v13, v38
    v_dot2_f32_bf16 v39, v19, v11, v39
    v_dot2_f32_bf16 v40, v20, v13, v40
    v_dot2_f32_bf16 v41, v20, v11, v41
    v_dot2_f32_bf16 v42, v21, v13, v42
    v_dot2_f32_bf16 v43, v21, v11, v43
    v_dot2_f32_bf16 v44, v22, v13, v44
    v_dot2_f32_bf16 v45, v22, v11, v45
    v_dot2_f32_bf16 v46, v23, v13, v46
    v_dot2_f32_bf16 v47, v23, v11, v47
    v_dot2_f32_bf16 v48, v24, v13, v48
    v_dot2_f32_bf16 v49, v24, v11, v49
    v_dot2_f32_bf16 v34, v16, v14, v34
    v_dot2_f32_bf16 v36, v17, v14, v36
    v_dot2_f32_bf16 v38, v18, v14, v38
    v_dot2_f32_bf16 v40, v19, v14, v40
    v_dot2_f32_bf16 v42, v20, v14, v42
    v_dot2_f32_bf16 v44, v21, v14, v44
    v_dot2_f32_bf16 v46, v22, v14, v46
    v_dot2_f32_bf16 v48, v23, v14, v48
    s_waitcnt lgkmcnt(0)
    v_lshlrev_b32 v110, 16, v26
    v_and_b32 v111, 0xffff0000, v26
    v_lshlrev_b32 v112, 16, v27
    v_and_b32 v113, 0xffff0000, v27
    v_lshlrev_b32 v114, 16, v28
    v_and_b32 v115, 0xffff0000, v28
    v_lshlrev_b32 v116, 16, v29
    v_and_b32 v117, 0xffff0000, v29
    v_mul_f32 v34, v34, v110
    v_mul_f32 v35, v35, v111
    v_mul_f32 v36, v36, v112
    v_mul_f32 v37, v37, v113
    v_mul_f32 v38, v38, v114
    v_mul_f32 v39, v39, v115
    v_mul_f32 v40, v40, v116
    v_mul_f32 v41, v41, v117
    v_cvt_pk_bf16_f32 v52, v41, v40
    v_cvt_pk_bf16_f32 v53, v39, v38
    v_cvt_pk_bf16_f32 v54, v37, v36
    v_cvt_pk_bf16_f32 v55, v35, v34
    buffer_store_dwordx4 v[52:55], v6, s[28:31], 0 offen offset:0
    v_lshlrev_b32 v118, 16, v30
    v_and_b32 v119, 0xffff0000, v30
    v_lshlrev_b32 v120, 16, v31
    v_and_b32 v121, 0xffff0000, v31
    v_lshlrev_b32 v122, 16, v32
    v_and_b32 v123, 0xffff0000, v32
    v_lshlrev_b32 v124, 16, v33
    v_and_b32 v125, 0xffff0000, v33
    v_mul_f32 v42, v42, v118
    v_mul_f32 v43, v43, v119
    v_mul_f32 v44, v44, v120
    v_mul_f32 v45, v45, v121
    v_mul_f32 v46, v46, v122
    v_mul_f32 v47, v47, v123
    v_mul_f32 v48, v48, v124
    v_mul_f32 v49, v49, v125
    v_cvt_pk_bf16_f32 v56, v49, v48
    v_cvt_pk_bf16_f32 v57, v47, v46
    v_cvt_pk_bf16_f32 v58, v45, v44
    v_cvt_pk_bf16_f32 v59, v43, v42
    buffer_store_dwordx4 v[56:59], v6, s[28:31], 0 offen offset:64
    s_cmp_ge_u32 s3, 4
    s_cbranch_scc1 KA_helper
    s_add_u32 s20, s10, 20971520
    s_addc_u32 s21, s11, 0
    s_mov_b32 s22, 14680064
    s_mov_b32 s23, 0x20000
    s_mul_i32 s49, s3, 16640
    s_lshr_b32 s47, s43, 5
    s_mul_i32 s47, s47, 112
    s_bfe_u32 s48, s43, 0x30002
    s_mul_i32 s60, s48, 7
    s_add_u32 s47, s47, s60
    s_and_b32 s48, s48, 1
    s_add_u32 s47, s47, s48
    s_and_b32 s48, s43, 3
    s_add_u32 s47, s47, s48
    s_lshl_b32 s47, s47, 10
    s_mul_i32 s48, s3, 3670016
    s_add_u32 s48, s48, s47
    v_lshl_add_u32 v4, v2, 4, s48
    s_mov_b32 s60, 917504
    s_mov_b32 s61, 1835008
    s_mov_b32 s62, 2752512
    v_and_b32 v7, 3, v2
    v_mul_u32_u24 v7, 4640, v7
    v_lshrrev_b32 v8, 2, v2
    v_lshlrev_b32 v8, 4, v8
    v_sub_u32 v7, v7, v8
    s_lshl_b32 s50, s3, 10
    s_sub_u32 s50, 69872, s50
    v_add_u32 v7, s50, v7
    v_mov_b32 v12, 0
    v_mov_b32 v13, 0
    v_mov_b32 v14, 0
    v_mov_b32 v15, 0
    s_mul_i32 s51, s3, 4640
    s_add_u32 s51, s51, 66560
    v_lshl_add_u32 v8, v2, 4, s51
    s_mov_b64 exec, 0x3fffffff
    ds_write_b128 v8, v[12:15] offset:4096
    s_mov_b64 exec, -1
    v_lshl_add_u32 v9, v2, 4, s49
    v_and_b32 v10, 15, v2
    v_lshrrev_b32 v11, 4, v2
    v_add_u32 v16, 1, v10
    v_and_b32 v17, 3, v16
    v_sub_u32 v16, v16, v17
    v_lshlrev_b32 v16, 1, v16
    v_mul_u32_u24 v17, 4160, v17
    v_add_u32 v16, v16, v17
    v_lshl_add_u32 v16, v11, 4, v16
    v_add_u32 v16, s49, v16
    v_lshlrev_b32 v17, 5, v10
    v_sub_u32 v17, 480, v17
    v_lshl_add_u32 v17, v11, 4, v17
    v_add_u32 v17, s51, v17
    v_lshlrev_b32 v18, 3, v11
    v_add_u32 v18, v18, v10
    v_sub_u32 v18, 15, v18
    v_mov_b32 v22, v127
    s_lshl_b32 s50, s45, 2
    v_mov_b32 v23, s50
    v_mov_b32 v28, s42
    s_add_u32 s50, s42, s41
    v_mov_b32 v30, s50
    v_cmp_le_u32 vcc, 128, v22
    s_nop 1
    v_cndmask_b32 v30, v30, v28, vcc
    s_waitcnt vmcnt(10)
    ds_write_b128 v9, v[128:131] offset:32
    v_alignbit_b32 v64, v129, v128, 16
    v_alignbit_b32 v65, v130, v129, 16
    v_alignbit_b32 v66, v131, v130, 16
    v_alignbit_b32 v67, v132, v131, 16
    ds_write_b128 v9, v[64:67] offset:4192
    v_mov_b32 v68, v129
    v_mov_b32 v69, v130
    v_mov_b32 v70, v131
    v_mov_b32 v71, v132
    ds_write_b128 v9, v[68:71] offset:8352
    v_alignbit_b32 v72, v130, v129, 16
    v_alignbit_b32 v73, v131, v130, 16
    v_alignbit_b32 v74, v132, v131, 16
    v_alignbit_b32 v75, v133, v132, 16
    ds_write_b128 v9, v[72:75] offset:12512
    s_waitcnt vmcnt(8)
    ds_write_b128 v9, v[134:137] offset:1056
    v_alignbit_b32 v76, v135, v134, 16
    v_alignbit_b32 v77, v136, v135, 16
    v_alignbit_b32 v78, v137, v136, 16
    v_alignbit_b32 v79, v138, v137, 16
    ds_write_b128 v9, v[76:79] offset:5216
    v_mov_b32 v80, v135
    v_mov_b32 v81, v136
    v_mov_b32 v82, v137
    v_mov_b32 v83, v138
    ds_write_b128 v9, v[80:83] offset:9376
    v_alignbit_b32 v84, v136, v135, 16
    v_alignbit_b32 v85, v137, v136, 16
    v_alignbit_b32 v86, v138, v137, 16
    v_alignbit_b32 v87, v139, v138, 16
    ds_write_b128 v9, v[84:87] offset:13536
    s_waitcnt vmcnt(6)
    ds_write_b128 v9, v[140:143] offset:2080
    v_alignbit_b32 v88, v141, v140, 16
    v_alignbit_b32 v89, v142, v141, 16
    v_alignbit_b32 v90, v143, v142, 16
    v_alignbit_b32 v91, v144, v143, 16
    ds_write_b128 v9, v[88:91] offset:6240
    v_mov_b32 v92, v141
    v_mov_b32 v93, v142
    v_mov_b32 v94, v143
    v_mov_b32 v95, v144
    ds_write_b128 v9, v[92:95] offset:10400
    v_alignbit_b32 v96, v142, v141, 16
    v_alignbit_b32 v97, v143, v142, 16
    v_alignbit_b32 v98, v144, v143, 16
    v_alignbit_b32 v99, v145, v144, 16
    ds_write_b128 v9, v[96:99] offset:14560
    s_waitcnt vmcnt(4)
    ds_write_b128 v9, v[146:149] offset:3104
    v_alignbit_b32 v100, v147, v146, 16
    v_alignbit_b32 v101, v148, v147, 16
    v_alignbit_b32 v102, v149, v148, 16
    v_alignbit_b32 v103, v150, v149, 16
    ds_write_b128 v9, v[100:103] offset:7264
    v_mov_b32 v104, v147
    v_mov_b32 v105, v148
    v_mov_b32 v106, v149
    v_mov_b32 v107, v150
    ds_write_b128 v9, v[104:107] offset:11424
    v_alignbit_b32 v108, v148, v147, 16
    v_alignbit_b32 v109, v149, v148, 16
    v_alignbit_b32 v110, v150, v149, 16
    v_alignbit_b32 v111, v151, v150, 16
    ds_write_b128 v9, v[108:111] offset:15584
    s_waitcnt vmcnt(0)
    s_barrier
    v_readfirstlane_b32 s54, v128
    v_readfirstlane_b32 s55, v129
    s_nop 1
    s_lshl_b32 s56, s54, 16
    s_lshr_b32 s57, s54, 16
    s_lshl_b32 s58, s55, 16
    s_or_b32 s57, s57, s58
    v_writelane_b32 v15, s56, 3
    v_writelane_b32 v15, s54, 5
    v_writelane_b32 v14, s56, 7
    v_writelane_b32 v15, s57, 7
    v_lshrrev_b32 v19, 1, v2
    v_mul_u32_u24 v19, 4160, v19
    v_and_b32 v20, 1, v2
    v_lshl_add_u32 v19, v20, 4, v19
    v_add_u32 v19, s49, v19
    s_mov_b64 exec, 0xff
    ds_write_b128 v19, v[12:15]
    s_mov_b64 exec, -1
    v_lshlrev_b32 v21, 16, v126
    v_cmp_eq_u32 vcc, 0, v18
    s_nop 1
    v_cndmask_b32 v24, 0, v126, vcc
    v_cmp_eq_u32 vcc, 1, v18
    s_nop 1
    v_cndmask_b32 v24, v24, v21, vcc
    v_cmp_eq_u32 vcc, 2, v18
    s_nop 1
    v_cndmask_b32 v25, 0, v126, vcc
    v_cmp_eq_u32 vcc, 3, v18
    s_nop 1
    v_cndmask_b32 v25, v25, v21, vcc
    v_cmp_eq_u32 vcc, 4, v18
    s_nop 1
    v_cndmask_b32 v26, 0, v126, vcc
    v_cmp_eq_u32 vcc, 5, v18
    s_nop 1
    v_cndmask_b32 v26, v26, v21, vcc
    v_cmp_eq_u32 vcc, 6, v18
    s_nop 1
    v_cndmask_b32 v27, 0, v126, vcc
    v_cmp_eq_u32 vcc, 7, v18
    s_nop 1
    v_cndmask_b32 v27, v27, v21, vcc
    s_waitcnt lgkmcnt(0)
    ds_read_b64 v[32:33], v16 offset:0
    ds_read_b64 v[34:35], v16 offset:8
    ds_read_b64 v[36:37], v16 offset:512
    ds_read_b64 v[38:39], v16 offset:520
    ds_read_b64 v[40:41], v16 offset:1024
    ds_read_b64 v[42:43], v16 offset:1032
    ds_read_b64 v[44:45], v16 offset:1536
    ds_read_b64 v[46:47], v16 offset:1544
    ds_read_b64 v[48:49], v16 offset:2048
    ds_read_b64 v[50:51], v16 offset:2056
    ds_read_b64 v[52:53], v16 offset:2560
    ds_read_b64 v[54:55], v16 offset:2568
    ds_read_b64 v[56:57], v16 offset:3072
    ds_read_b64 v[58:59], v16 offset:3080
    ds_read_b64 v[60:61], v16 offset:3584
    ds_read_b64 v[62:63], v16 offset:3592
    s_mov_b32 s59, 0
    s_cmp_eq_u32 s3, 0
    s_cselect_b32 s58, 32, -1
KA_poll:
    s_cmp_lg_u32 s59, s58
    s_cbranch_scc1 KA_norel
    buffer_wbl2 sc1
    s_waitcnt vmcnt(0)
    s_mov_b64 exec, 1
    buffer_store_dword v28, v23, s[24:27], 0 offen offset:128 sc1
    s_mov_b64 exec, -1
KA_norel:
    buffer_load_dword v29, v22, s[24:27], 0 offen sc1
    s_add_u32 s59, s59, 1
    s_waitcnt vmcnt(0)
    v_cmp_eq_u32 vcc, v30, v29
    s_cmp_gt_u32 s59, 65536
    s_cbranch_scc1 KA_poll_x
    s_lshr_b32 s57, vcc_lo, 16
    s_or_b32 s57, s57, vcc_lo
    s_and_b32 s57, s57, 0xffff
    s_cmp_lg_u32 s57, 0xffff
    s_cbranch_scc1 KA_poll
KA_poll_x:
    s_and_b32 s57, vcc_lo, 0xffff
    s_cmp_eq_u32 s57, 0xffff
    s_cbranch_scc1 KA_near
    s_cmp_gt_u32 s59, s58
    s_cbranch_scc1 KA_acq
    s_cmp_lg_u32 s3, 0
    s_cbranch_scc1 KA_acq
    buffer_wbl2 sc1
    s_waitcnt vmcnt(0)
    s_mov_b64 exec, 1
    buffer_store_dword v28, v23, s[24:27], 0 offen offset:128 sc1
    s_mov_b64 exec, -1
KA_acq:
    buffer_inv sc1
    s_waitcnt vmcnt(0)
KA_near:
    buffer_load_dwordx4 v[176:179], v4, s[28:31], 0 offen sc1
    buffer_load_dwordx4 v[180:183], v4, s[28:31], s60 offen sc1
    buffer_load_dwordx4 v[184:187], v4, s[28:31], s61 offen sc1
    buffer_load_dwordx4 v[188:191], v4, s[28:31], s62 offen sc1
    s_barrier
    s_waitcnt vmcnt(3)
    ds_write_b128 v7, v[176:179] offset:768
    s_waitcnt vmcnt(2)
    ds_write_b128 v7, v[180:183] offset:512
    s_waitcnt vmcnt(1)
    ds_write_b128 v7, v[184:187] offset:256
    s_waitcnt vmcnt(0)
    ds_write_b128 v7, v[188:191] offset:0
    s_waitcnt lgkmcnt(0)
    s_barrier
    ds_read_b128 v[64:67], v17 offset:3584
    ds_read_b128 v[68:71], v17 offset:3072
    ds_read_b128 v[72:75], v17 offset:2560
    ds_read_b128 v[76:79], v17 offset:2048
    ds_read_b128 v[80:83], v17 offset:1536
    ds_read_b128 v[84:87], v17 offset:1024
    ds_read_b128 v[88:91], v17 offset:512
    ds_read_b128 v[92:95], v17 offset:0
    s_lshr_b32 s58, s2, 3
    s_lshl_b32 s58, s58, 2
    s_add_u32 s58, s58, s3
    s_cmp_eq_u32 s58, 124
    s_cselect_b32 s58, 0, 99
    s_waitcnt lgkmcnt(7)
    v_mfma_f32_16x16x32_bf16 v[192:195], v[24:27], v[64:67], 0
    s_waitcnt lgkmcnt(6)
    v_mfma_f32_16x16x32_bf16 v[196:199], v[24:27], v[68:71], 0
    s_waitcnt lgkmcnt(5)
    v_mfma_f32_16x16x32_bf16 v[200:203], v[24:27], v[72:75], 0
    s_waitcnt lgkmcnt(4)
    v_mfma_f32_16x16x32_bf16 v[204:207], v[24:27], v[76:79], 0
    s_waitcnt lgkmcnt(3)
    v_mfma_f32_16x16x32_bf16 v[208:211], v[24:27], v[80:83], 0
    s_waitcnt lgkmcnt(2)
    v_mfma_f32_16x16x32_bf16 v[212:215], v[24:27], v[84:87], 0
    s_waitcnt lgkmcnt(1)
    v_mfma_f32_16x16x32_bf16 v[216:219], v[24:27], v[88:91], 0
    s_waitcnt lgkmcnt(0)
    v_mfma_f32_16x16x32_bf16 v[220:223], v[24:27], v[92:95], 0
    s_mov_b32 s59, 0
KA_loop:
    v_mfma_f32_16x16x32_bf16 v[192:195], v[32:35], v[64:67], v[192:195]
    ds_read_b64 v[96:97], v16 offset:64
    v_mfma_f32_16x16x32_bf16 v[196:199], v[32:35], v[68:71], v[196:199]
    ds_read_b64 v[98:99], v16 offset:72
    v_mfma_f32_16x16x32_bf16 v[200:203], v[32:35], v[72:75], v[200:203]
    ds_read_b128 v[128:131], v17 offset:3648
    v_mfma_f32_16x16x32_bf16 v[204:207], v[32:35], v[76:79], v[204:207]
    ds_read_b128 v[132:135], v17 offset:3136
    v_mfma_f32_16x16x32_bf16 v[208:211], v[32:35], v[80:83], v[208:211]
    ds_read_b128 v[136:139], v17 offset:2624
    v_mfma_f32_16x16x32_bf16 v[212:215], v[32:35], v[84:87], v[212:215]
    ds_read_b128 v[140:143], v17 offset:2112
    v_mfma_f32_16x16x32_bf16 v[216:219], v[32:35], v[88:91], v[216:219]
    ds_read_b128 v[144:147], v17 offset:1600
    v_mfma_f32_16x16x32_bf16 v[220:223], v[32:35], v[92:95], v[220:223]
    ds_read_b128 v[148:151], v17 offset:1088
    v_mfma_f32_16x16x32_bf16 v[196:199], v[36:39], v[64:67], v[196:199]
    ds_read_b128 v[152:155], v17 offset:576
    v_mfma_f32_16x16x32_bf16 v[200:203], v[36:39], v[68:71], v[200:203]
    ds_read_b128 v[156:159], v17 offset:64
    v_mfma_f32_16x16x32_bf16 v[204:207], v[36:39], v[72:75], v[204:207]
    ds_read_b64 v[100:101], v16 offset:576
    v_mfma_f32_16x16x32_bf16 v[208:211], v[36:39], v[76:79], v[208:211]
    ds_read_b64 v[102:103], v16 offset:584
    v_mfma_f32_16x16x32_bf16 v[212:215], v[36:39], v[80:83], v[212:215]
    ds_read_b64 v[104:105], v16 offset:1088
    v_mfma_f32_16x16x32_bf16 v[216:219], v[36:39], v[84:87], v[216:219]
    ds_read_b64 v[106:107], v16 offset:1096
    v_mfma_f32_16x16x32_bf16 v[220:223], v[36:39], v[88:91], v[220:223]
    ds_read_b64 v[108:109], v16 offset:1600
    v_mfma_f32_16x16x32_bf16 v[200:203], v[40:43], v[64:67], v[200:203]
    ds_read_b64 v[110:111], v16 offset:1608
    v_mfma_f32_16x16x32_bf16 v[204:207], v[40:43], v[68:71], v[204:207]
    ds_read_b64 v[112:113], v16 offset:2112
    v_mfma_f32_16x16x32_bf16 v[208:211], v[40:43], v[72:75], v[208:211]
    ds_read_b64 v[114:115], v16 offset:2120
    v_mfma_f32_16x16x32_bf16 v[212:215], v[40:43], v[76:79], v[212:215]
    ds_read_b64 v[116:117], v16 offset:2624
    v_mfma_f32_16x16x32_bf16 v[216:219], v[40:43], v[80:83], v[216:219]
    ds_read_b64 v[118:119], v16 offset:2632
    v_mfma_f32_16x16x32_bf16 v[220:223], v[40:43], v[84:87], v[220:223]
    ds_read_b64 v[120:121], v16 offset:3136
    v_mfma_f32_16x16x32_bf16 v[204:207], v[44:47], v[64:67], v[204:207]
    ds_read_b64 v[122:123], v16 offset:3144
    v_mfma_f32_16x16x32_bf16 v[208:211], v[44:47], v[68:71], v[208:211]
    ds_read_b64 v[124:125], v16 offset:3648
    v_mfma_f32_16x16x32_bf16 v[212:215], v[44:47], v[72:75], v[212:215]
    ds_read_b64 v[126:127], v16 offset:3656
    v_mfma_f32_16x16x32_bf16 v[216:219], v[44:47], v[76:79], v[216:219]
    v_mfma_f32_16x16x32_bf16 v[220:223], v[44:47], v[80:83], v[220:223]
    v_mfma_f32_16x16x32_bf16 v[208:211], v[48:51], v[64:67], v[208:211]
    v_mfma_f32_16x16x32_bf16 v[212:215], v[48:51], v[68:71], v[212:215]
    v_mfma_f32_16x16x32_bf16 v[216:219], v[48:51], v[72:75], v[216:219]
    v_mfma_f32_16x16x32_bf16 v[220:223], v[48:51], v[76:79], v[220:223]
    s_barrier
    v_mfma_f32_16x16x32_bf16 v[212:215], v[52:55], v[64:67], v[212:215]
    v_mfma_f32_16x16x32_bf16 v[216:219], v[52:55], v[68:71], v[216:219]
    v_mfma_f32_16x16x32_bf16 v[220:223], v[52:55], v[72:75], v[220:223]
    v_mfma_f32_16x16x32_bf16 v[216:219], v[56:59], v[64:67], v[216:219]
    v_mfma_f32_16x16x32_bf16 v[220:223], v[56:59], v[68:71], v[220:223]
    s_waitcnt lgkmcnt(0)
    v_mfma_f32_16x16x32_bf16 v[220:223], v[60:63], v[64:67], v[220:223]
    v_mfma_f32_16x16x32_bf16 v[192:195], v[96:99], v[128:131], v[192:195]
    ds_read_b64 v[32:33], v16 offset:128
    v_mfma_f32_16x16x32_bf16 v[196:199], v[96:99], v[132:135], v[196:199]
    ds_read_b64 v[34:35], v16 offset:136
    v_mfma_f32_16x16x32_bf16 v[200:203], v[96:99], v[136:139], v[200:203]
    ds_read_b128 v[64:67], v17 offset:3712
    v_mfma_f32_16x16x32_bf16 v[204:207], v[96:99], v[140:143], v[204:207]
    ds_read_b128 v[68:71], v17 offset:3200
    v_mfma_f32_16x16x32_bf16 v[208:211], v[96:99], v[144:147], v[208:211]
    ds_read_b128 v[72:75], v17 offset:2688
    v_mfma_f32_16x16x32_bf16 v[212:215], v[96:99], v[148:151], v[212:215]
    ds_read_b128 v[76:79], v17 offset:2176
    v_mfma_f32_16x16x32_bf16 v[216:219], v[96:99], v[152:155], v[216:219]
    ds_read_b128 v[80:83], v17 offset:1664
    v_mfma_f32_16x16x32_bf16 v[220:223], v[96:99], v[156:159], v[220:223]
    ds_read_b128 v[84:87], v17 offset:1152
    v_mfma_f32_16x16x32_bf16 v[196:199], v[100:103], v[128:131], v[196:199]
    ds_read_b128 v[88:91], v17 offset:640
    v_mfma_f32_16x16x32_bf16 v[200:203], v[100:103], v[132:135], v[200:203]
    ds_read_b128 v[92:95], v17 offset:128
    v_mfma_f32_16x16x32_bf16 v[204:207], v[100:103], v[136:139], v[204:207]
    ds_read_b64 v[36:37], v16 offset:640
    v_mfma_f32_16x16x32_bf16 v[208:211], v[100:103], v[140:143], v[208:211]
    ds_read_b64 v[38:39], v16 offset:648
    v_mfma_f32_16x16x32_bf16 v[212:215], v[100:103], v[144:147], v[212:215]
    ds_read_b64 v[40:41], v16 offset:1152
    v_mfma_f32_16x16x32_bf16 v[216:219], v[100:103], v[148:151], v[216:219]
    ds_read_b64 v[42:43], v16 offset:1160
    v_mfma_f32_16x16x32_bf16 v[220:223], v[100:103], v[152:155], v[220:223]
    ds_read_b64 v[44:45], v16 offset:1664
    v_mfma_f32_16x16x32_bf16 v[200:203], v[104:107], v[128:131], v[200:203]
    ds_read_b64 v[46:47], v16 offset:1672
    v_mfma_f32_16x16x32_bf16 v[204:207], v[104:107], v[132:135], v[204:207]
    ds_read_b64 v[48:49], v16 offset:2176
    v_mfma_f32_16x16x32_bf16 v[208:211], v[104:107], v[136:139], v[208:211]
    ds_read_b64 v[50:51], v16 offset:2184
    v_mfma_f32_16x16x32_bf16 v[212:215], v[104:107], v[140:143], v[212:215]
    ds_read_b64 v[52:53], v16 offset:2688
    v_mfma_f32_16x16x32_bf16 v[216:219], v[104:107], v[144:147], v[216:219]
    ds_read_b64 v[54:55], v16 offset:2696
    v_mfma_f32_16x16x32_bf16 v[220:223], v[104:107], v[148:151], v[220:223]
    ds_read_b64 v[56:57], v16 offset:3200
    v_mfma_f32_16x16x32_bf16 v[204:207], v[108:111], v[128:131], v[204:207]
    ds_read_b64 v[58:59], v16 offset:3208
    v_mfma_f32_16x16x32_bf16 v[208:211], v[108:111], v[132:135], v[208:211]
    ds_read_b64 v[60:61], v16 offset:3712
    v_mfma_f32_16x16x32_bf16 v[212:215], v[108:111], v[136:139], v[212:215]
    ds_read_b64 v[62:63], v16 offset:3720
    v_mfma_f32_16x16x32_bf16 v[216:219], v[108:111], v[140:143], v[216:219]
    v_add_u32 v16, 128, v16
    v_mfma_f32_16x16x32_bf16 v[220:223], v[108:111], v[144:147], v[220:223]
    v_add_u32 v17, 128, v17
    v_mfma_f32_16x16x32_bf16 v[208:211], v[112:115], v[128:131], v[208:211]
    s_add_u32 s59, s59, 1
    v_mfma_f32_16x16x32_bf16 v[212:215], v[112:115], v[132:135], v[212:215]
    s_cmp_lt_u32 s59, 4
    v_mfma_f32_16x16x32_bf16 v[216:219], v[112:115], v[136:139], v[216:219]
    v_mfma_f32_16x16x32_bf16 v[220:223], v[112:115], v[140:143], v[220:223]
    s_barrier
    v_mfma_f32_16x16x32_bf16 v[212:215], v[116:119], v[128:131], v[212:215]
    v_mfma_f32_16x16x32_bf16 v[216:219], v[116:119], v[132:135], v[216:219]
    v_mfma_f32_16x16x32_bf16 v[220:223], v[116:119], v[136:139], v[220:223]
    v_mfma_f32_16x16x32_bf16 v[216:219], v[120:123], v[128:131], v[216:219]
    v_mfma_f32_16x16x32_bf16 v[220:223], v[120:123], v[132:135], v[220:223]
    s_waitcnt lgkmcnt(0)
    v_mfma_f32_16x16x32_bf16 v[220:223], v[124:127], v[128:131], v[220:223]
    s_cbranch_scc1 KA_loop
    v_lshlrev_b32 v20, 5, v10
    v_lshl_add_u32 v20, v11, 3, v20
    v_add_u32 v20, s49, v20
    s_lshl_b32 s50, s3, 10
    v_lshl_add_u32 v21, v2, 2, s50
    s_mov_b32 s56, 0x05040100
    s_mov_b32 s57, 0x07060302
    v_cvt_pk_bf16_f32 v32, v192, v193
    v_cvt_pk_bf16_f32 v33, v194, v195
    ds_write_b64 v20, v[32:33] offset:0
    v_cvt_pk_bf16_f32 v34, v196, v197
    v_cvt_pk_bf16_f32 v35, v198, v199
    ds_write_b64 v20, v[34:35] offset:512
    v_cvt_pk_bf16_f32 v36, v200, v201
    v_cvt_pk_bf16_f32 v37, v202, v203
    ds_write_b64 v20, v[36:37] offset:1024
    v_cvt_pk_bf16_f32 v38, v204, v205
    v_cvt_pk_bf16_f32 v39, v206, v207
    ds_write_b64 v20, v[38:39] offset:1536
    v_cvt_pk_bf16_f32 v40, v208, v209
    v_cvt_pk_bf16_f32 v41, v210, v211
    ds_write_b64 v20, v[40:41] offset:2048
    v_cvt_pk_bf16_f32 v42, v212, v213
    v_cvt_pk_bf16_f32 v43, v214, v215
    ds_write_b64 v20, v[42:43] offset:2560
    v_cvt_pk_bf16_f32 v44, v216, v217
    v_cvt_pk_bf16_f32 v45, v218, v219
    ds_write_b64 v20, v[44:45] offset:3072
    v_cvt_pk_bf16_f32 v46, v220, v221
    v_cvt_pk_bf16_f32 v47, v222, v223
    ds_write_b64 v20, v[46:47] offset:3584
    s_waitcnt lgkmcnt(0)
    s_barrier
    ds_read2st64_b32 v[64:65], v21 offset0:0 offset1:65
    ds_read2st64_b32 v[66:67], v21 offset0:130 offset1:195
    ds_read2st64_b32 v[68:69], v21 offset0:1 offset1:66
    ds_read2st64_b32 v[70:71], v21 offset0:131 offset1:196
    ds_read2st64_b32 v[72:73], v21 offset0:2 offset1:67
    ds_read2st64_b32 v[74:75], v21 offset0:132 offset1:197
    ds_read2st64_b32 v[76:77], v21 offset0:3 offset1:68
    ds_read2st64_b32 v[78:79], v21 offset0:133 offset1:198
    s_waitcnt lgkmcnt(6)
    v_perm_b32 v96, v65, v64, s56
    v_perm_b32 v97, v67, v66, s56
    v_perm_b32 v98, v65, v64, s57
    v_perm_b32 v99, v67, v66, s57
    buffer_store_dwordx4 v[96:99], v4, s[20:23], 0 offen sc1
    s_waitcnt lgkmcnt(4)
    v_perm_b32 v100, v69, v68, s56
    v_perm_b32 v101, v71, v70, s56
    v_perm_b32 v102, v69, v68, s57
    v_perm_b32 v103, v71, v70, s57
    buffer_store_dwordx4 v[100:103], v4, s[20:23], s60 offen sc1
    s_waitcnt lgkmcnt(2)
    v_perm_b32 v104, v73, v72, s56
    v_perm_b32 v105, v75, v74, s56
    v_perm_b32 v106, v73, v72, s57
    v_perm_b32 v107, v75, v74, s57
    buffer_store_dwordx4 v[104:107], v4, s[20:23], s61 offen sc1
    s_waitcnt lgkmcnt(0)
    v_perm_b32 v108, v77, v76, s56
    v_perm_b32 v109, v79, v78, s56
    v_perm_b32 v110, v77, v76, s57
    v_perm_b32 v111, v79, v78, s57
    buffer_store_dwordx4 v[108:111], v4, s[20:23], s62 offen sc1
    s_or_b32 s59, s3, s45
    s_cmp_lg_u32 s59, 0
    s_cbranch_scc1 KA_noep
    s_mov_b64 exec, 1
    buffer_store_dword v28, v23, s[24:27], 0 offen offset:256 sc1
KA_noep:
    s_endpgm
KA_helper:
    s_mov_b32 s63, 12288
    s_cmp_lt_u32 s2, 192
    s_cbranch_scc1 KA_isgemv
    s_mov_b32 s36, s6
    s_mov_b32 s37, s7
    s_mov_b32 s38, 4194304
    s_bfe_u32 s54, s2, 0x20001
    s_lshl_b32 s54, s54, 3
    s_lshr_b32 s55, s2, 3
    s_sub_u32 s55, s55, 24
    s_add_u32 s54, s54, s55
    s_lshl_b32 s54, s54, 1
    s_and_b32 s55, s2, 1
    s_add_u32 s54, s54, s55
    s_lshl_b32 s54, s54, 16
    s_lshl_b32 s55, s60, 14
    s_add_u32 s54, s54, s55
    v_lshl_add_u32 v108, v2, 4, s54
    s_mov_b32 s63, 1024
KA_isgemv:
    s_mov_b32 s55, 0
    buffer_load_dwordx4 v[128:131], v108, s[36:39], s55 offen
    s_add_u32 s55, s55, s63
    buffer_load_dwordx4 v[132:135], v108, s[36:39], s55 offen
    s_add_u32 s55, s55, s63
    buffer_load_dwordx4 v[136:139], v108, s[36:39], s55 offen
    s_add_u32 s55, s55, s63
    buffer_load_dwordx4 v[140:143], v108, s[36:39], s55 offen
    s_add_u32 s55, s55, s63
    buffer_load_dwordx4 v[144:147], v108, s[36:39], s55 offen
    s_add_u32 s55, s55, s63
    buffer_load_dwordx4 v[148:151], v108, s[36:39], s55 offen
    s_add_u32 s55, s55, s63
    buffer_load_dwordx4 v[152:155], v108, s[36:39], s55 offen
    s_add_u32 s55, s55, s63
    buffer_load_dwordx4 v[156:159], v108, s[36:39], s55 offen
    s_add_u32 s55, s55, s63
    s_waitcnt vmcnt(10)
    v_lshlrev_b32 v16, 16, v64
    v_and_b32 v17, 0xffff0000, v64
    v_lshlrev_b32 v18, 16, v65
    v_and_b32 v19, 0xffff0000, v65
    v_lshlrev_b32 v20, 16, v66
    v_and_b32 v21, 0xffff0000, v66
    v_lshlrev_b32 v22, 16, v67
    v_and_b32 v23, 0xffff0000, v67
    v_lshlrev_b32 v24, 16, v68
    v_and_b32 v25, 0xffff0000, v68
    v_lshlrev_b32 v26, 16, v69
    v_and_b32 v27, 0xffff0000, v69
    v_lshlrev_b32 v28, 16, v70
    v_and_b32 v29, 0xffff0000, v70
    v_lshlrev_b32 v30, 16, v71
    v_and_b32 v31, 0xffff0000, v71
    v_mul_f32 v32, 0xbfb8aa3b, v16
    v_mul_f32 v33, 0xbfb8aa3b, v17
    v_mul_f32 v34, 0xbfb8aa3b, v18
    v_mul_f32 v35, 0xbfb8aa3b, v19
    v_mul_f32 v36, 0xbfb8aa3b, v20
    v_mul_f32 v37, 0xbfb8aa3b, v21
    v_mul_f32 v38, 0xbfb8aa3b, v22
    v_mul_f32 v39, 0xbfb8aa3b, v23
    v_mul_f32 v40, 0xbfb8aa3b, v24
    v_mul_f32 v41, 0xbfb8aa3b, v25
    v_mul_f32 v42, 0xbfb8aa3b, v26
    v_mul_f32 v43, 0xbfb8aa3b, v27
    v_mul_f32 v44, 0xbfb8aa3b, v28
    v_mul_f32 v45, 0xbfb8aa3b, v29
    v_mul_f32 v46, 0xbfb8aa3b, v30
    v_mul_f32 v47, 0xbfb8aa3b, v31
    v_exp_f32 v32, v32
    v_exp_f32 v33, v33
    v_exp_f32 v34, v34
    v_exp_f32 v35, v35
    v_exp_f32 v36, v36
    v_exp_f32 v37, v37
    v_exp_f32 v38, v38
    v_exp_f32 v39, v39
    v_exp_f32 v40, v40
    v_exp_f32 v41, v41
    v_exp_f32 v42, v42
    v_exp_f32 v43, v43
    v_exp_f32 v44, v44
    v_exp_f32 v45, v45
    v_exp_f32 v46, v46
    v_exp_f32 v47, v47
    s_waitcnt vmcnt(8)
    s_barrier
    s_cmp_lg_u32 s60, 0
    s_cbranch_scc1 KA_nopost
    s_mov_b64 exec, 1
    buffer_store_dword v73, v72, s[64:67], 0 offen
    s_mov_b64 exec, -1
KA_nopost:
    v_add_f32 v32, 1.0, v32
    v_add_f32 v33, 1.0, v33
    v_add_f32 v34, 1.0, v34
    v_add_f32 v35, 1.0, v35
    v_add_f32 v36, 1.0, v36
    v_add_f32 v37, 1.0, v37
    v_add_f32 v38, 1.0, v38
    v_add_f32 v39, 1.0, v39
    v_add_f32 v40, 1.0, v40
    v_add_f32 v41, 1.0, v41
    v_add_f32 v42, 1.0, v42
    v_add_f32 v43, 1.0, v43
    v_add_f32 v44, 1.0, v44
    v_add_f32 v45, 1.0, v45
    v_add_f32 v46, 1.0, v46
    v_add_f32 v47, 1.0, v47
    v_rcp_f32 v32, v32
    v_rcp_f32 v33, v33
    v_rcp_f32 v34, v34
    v_rcp_f32 v35, v35
    v_rcp_f32 v36, v36
    v_rcp_f32 v37, v37
    v_rcp_f32 v38, v38
    v_rcp_f32 v39, v39
    v_rcp_f32 v40, v40
    v_rcp_f32 v41, v41
    v_rcp_f32 v42, v42
    v_rcp_f32 v43, v43
    v_rcp_f32 v44, v44
    v_rcp_f32 v45, v45
    v_rcp_f32 v46, v46
    v_rcp_f32 v47, v47
    v_mul_f32 v16, v16, v32
    v_mul_f32 v17, v17, v33
    v_mul_f32 v18, v18, v34
    v_mul_f32 v19, v19, v35
    v_mul_f32 v20, v20, v36
    v_mul_f32 v21, v21, v37
    v_mul_f32 v22, v22, v38
    v_mul_f32 v23, v23, v39
    v_mul_f32 v24, v24, v40
    v_mul_f32 v25, v25, v41
    v_mul_f32 v26, v26, v42
    v_mul_f32 v27, v27, v43
    v_mul_f32 v28, v28, v44
    v_mul_f32 v29, v29, v45
    v_mul_f32 v30, v30, v46
    v_mul_f32 v31, v31, v47
    v_cvt_pk_bf16_f32 v96, v16, v17
    v_cvt_pk_bf16_f32 v97, v18, v19
    v_cvt_pk_bf16_f32 v98, v20, v21
    v_cvt_pk_bf16_f32 v99, v22, v23
    v_cvt_pk_bf16_f32 v100, v24, v25
    v_cvt_pk_bf16_f32 v101, v26, v27
    v_cvt_pk_bf16_f32 v102, v28, v29
    v_cvt_pk_bf16_f32 v103, v30, v31
    v_lshlrev_b32 v16, 16, v96
    v_and_b32 v17, 0xffff0000, v96
    v_lshlrev_b32 v18, 16, v97
    v_and_b32 v19, 0xffff0000, v97
    v_lshlrev_b32 v20, 16, v98
    v_and_b32 v21, 0xffff0000, v98
    v_lshlrev_b32 v22, 16, v99
    v_and_b32 v23, 0xffff0000, v99
    v_lshlrev_b32 v24, 16, v100
    v_and_b32 v25, 0xffff0000, v100
    v_lshlrev_b32 v26, 16, v101
    v_and_b32 v27, 0xffff0000, v101
    v_lshlrev_b32 v28, 16, v102
    v_and_b32 v29, 0xffff0000, v102
    v_lshlrev_b32 v30, 16, v103
    v_and_b32 v31, 0xffff0000, v103
    s_barrier
    s_barrier
    s_getpc_b64 s[68:69]
KA_pcref:
    s_lshr_b32 s54, s2, 3
    s_lshl_b32 s54, s54, 2
    s_add_u32 s54, s54, s60
    s_lshl_b32 s54, s54, 6
    s_add_u32 s54, s54, km_kernel-KA_pcref
    s_load_dword s70, s[68:69], s54
    s_mov_b32 s24, s6
    s_mov_b32 s25, s7
    s_mov_b32 s26, 4194304
    s_mov_b32 s27, 0x20000
    s_bfe_u32 s54, s2, 0x20001
    s_lshl_b32 s54, s54, 2
    s_lshr_b32 s56, s2, 6
    s_add_u32 s54, s54, s56
    s_lshl_b32 s54, s54, 1
    s_bfe_u32 s56, s2, 0x10005
    s_add_u32 s54, s54, s56
    s_lshl_b32 s54, s54, 1
    s_and_b32 s56, s2, 1
    s_add_u32 s54, s54, s56
    s_lshl_b32 s54, s54, 2
    s_bfe_u32 s56, s2, 0x20003
    s_add_u32 s54, s54, s56
    s_lshl_b32 s54, s54, 14
    s_lshl_b32 s56, s60, 12
    s_add_u32 s54, s54, s56
    v_lshl_add_u32 v109, v2, 4, s54
    s_barrier
    s_waitcnt vmcnt(7)
    v_lshlrev_b32 v48, 16, v128
    v_and_b32 v49, 0xffff0000, v128
    v_lshlrev_b32 v50, 16, v129
    v_and_b32 v51, 0xffff0000, v129
    v_lshlrev_b32 v52, 16, v130
    v_and_b32 v53, 0xffff0000, v130
    v_lshlrev_b32 v54, 16, v131
    v_and_b32 v55, 0xffff0000, v131
    v_mul_f32 v32, v48, v16
    v_mul_f32 v33, v49, v16
    v_mul_f32 v34, v50, v16
    v_mul_f32 v35, v51, v16
    v_mul_f32 v36, v52, v16
    v_mul_f32 v37, v53, v16
    v_mul_f32 v38, v54, v16
    v_mul_f32 v39, v55, v16
    s_waitcnt vmcnt(6)
    v_lshlrev_b32 v56, 16, v132
    v_and_b32 v57, 0xffff0000, v132
    v_lshlrev_b32 v58, 16, v133
    v_and_b32 v59, 0xffff0000, v133
    v_lshlrev_b32 v60, 16, v134
    v_and_b32 v61, 0xffff0000, v134
    v_lshlrev_b32 v62, 16, v135
    v_and_b32 v63, 0xffff0000, v135
    v_fmac_f32 v32, v56, v17
    v_fmac_f32 v33, v57, v17
    v_fmac_f32 v34, v58, v17
    v_fmac_f32 v35, v59, v17
    v_fmac_f32 v36, v60, v17
    v_fmac_f32 v37, v61, v17
    v_fmac_f32 v38, v62, v17
    v_fmac_f32 v39, v63, v17
    s_waitcnt vmcnt(5)
    v_lshlrev_b32 v48, 16, v136
    v_and_b32 v49, 0xffff0000, v136
    v_lshlrev_b32 v50, 16, v137
    v_and_b32 v51, 0xffff0000, v137
    v_lshlrev_b32 v52, 16, v138
    v_and_b32 v53, 0xffff0000, v138
    v_lshlrev_b32 v54, 16, v139
    v_and_b32 v55, 0xffff0000, v139
    v_fmac_f32 v32, v48, v18
    v_fmac_f32 v33, v49, v18
    v_fmac_f32 v34, v50, v18
    v_fmac_f32 v35, v51, v18
    v_fmac_f32 v36, v52, v18
    v_fmac_f32 v37, v53, v18
    v_fmac_f32 v38, v54, v18
    v_fmac_f32 v39, v55, v18
    s_barrier
    buffer_load_dwordx4 v[160:163], v108, s[36:39], s55 offen
    s_add_u32 s55, s55, s63
    s_waitcnt vmcnt(5)
    v_lshlrev_b32 v56, 16, v140
    v_and_b32 v57, 0xffff0000, v140
    v_lshlrev_b32 v58, 16, v141
    v_and_b32 v59, 0xffff0000, v141
    v_lshlrev_b32 v60, 16, v142
    v_and_b32 v61, 0xffff0000, v142
    v_lshlrev_b32 v62, 16, v143
    v_and_b32 v63, 0xffff0000, v143
    v_fmac_f32 v32, v56, v19
    v_fmac_f32 v33, v57, v19
    v_fmac_f32 v34, v58, v19
    v_fmac_f32 v35, v59, v19
    v_fmac_f32 v36, v60, v19
    v_fmac_f32 v37, v61, v19
    v_fmac_f32 v38, v62, v19
    v_fmac_f32 v39, v63, v19
    s_waitcnt vmcnt(4)
    v_lshlrev_b32 v48, 16, v144
    v_and_b32 v49, 0xffff0000, v144
    v_lshlrev_b32 v50, 16, v145
    v_and_b32 v51, 0xffff0000, v145
    v_lshlrev_b32 v52, 16, v146
    v_and_b32 v53, 0xffff0000, v146
    v_lshlrev_b32 v54, 16, v147
    v_and_b32 v55, 0xffff0000, v147
    v_fmac_f32 v32, v48, v20
    v_fmac_f32 v33, v49, v20
    v_fmac_f32 v34, v50, v20
    v_fmac_f32 v35, v51, v20
    v_fmac_f32 v36, v52, v20
    v_fmac_f32 v37, v53, v20
    v_fmac_f32 v38, v54, v20
    v_fmac_f32 v39, v55, v20
    s_waitcnt vmcnt(3)
    v_lshlrev_b32 v56, 16, v148
    v_and_b32 v57, 0xffff0000, v148
    v_lshlrev_b32 v58, 16, v149
    v_and_b32 v59, 0xffff0000, v149
    v_lshlrev_b32 v60, 16, v150
    v_and_b32 v61, 0xffff0000, v150
    v_lshlrev_b32 v62, 16, v151
    v_and_b32 v63, 0xffff0000, v151
    v_fmac_f32 v32, v56, v21
    v_fmac_f32 v33, v57, v21
    v_fmac_f32 v34, v58, v21
    v_fmac_f32 v35, v59, v21
    v_fmac_f32 v36, v60, v21
    v_fmac_f32 v37, v61, v21
    v_fmac_f32 v38, v62, v21
    v_fmac_f32 v39, v63, v21
    s_barrier
    buffer_load_dwordx4 v[164:167], v108, s[36:39], s55 offen
    s_add_u32 s55, s55, s63
    s_waitcnt vmcnt(3)
    v_lshlrev_b32 v48, 16, v152
    v_and_b32 v49, 0xffff0000, v152
    v_lshlrev_b32 v50, 16, v153
    v_and_b32 v51, 0xffff0000, v153
    v_lshlrev_b32 v52, 16, v154
    v_and_b32 v53, 0xffff0000, v154
    v_lshlrev_b32 v54, 16, v155
    v_and_b32 v55, 0xffff0000, v155
    v_fmac_f32 v32, v48, v22
    v_fmac_f32 v33, v49, v22
    v_fmac_f32 v34, v50, v22
    v_fmac_f32 v35, v51, v22
    v_fmac_f32 v36, v52, v22
    v_fmac_f32 v37, v53, v22
    v_fmac_f32 v38, v54, v22
    v_fmac_f32 v39, v55, v22
    s_waitcnt vmcnt(2)
    v_lshlrev_b32 v56, 16, v156
    v_and_b32 v57, 0xffff0000, v156
    v_lshlrev_b32 v58, 16, v157
    v_and_b32 v59, 0xffff0000, v157
    v_lshlrev_b32 v60, 16, v158
    v_and_b32 v61, 0xffff0000, v158
    v_lshlrev_b32 v62, 16, v159
    v_and_b32 v63, 0xffff0000, v159
    v_fmac_f32 v32, v56, v23
    v_fmac_f32 v33, v57, v23
    v_fmac_f32 v34, v58, v23
    v_fmac_f32 v35, v59, v23
    v_fmac_f32 v36, v60, v23
    v_fmac_f32 v37, v61, v23
    v_fmac_f32 v38, v62, v23
    v_fmac_f32 v39, v63, v23
    s_barrier
    buffer_load_dwordx4 v[168:171], v108, s[36:39], s55 offen
    s_add_u32 s55, s55, s63
    buffer_load_dwordx4 v[172:175], v108, s[36:39], s55 offen
    s_add_u32 s55, s55, s63
    s_waitcnt vmcnt(3)
    v_lshlrev_b32 v48, 16, v160
    v_and_b32 v49, 0xffff0000, v160
    v_lshlrev_b32 v50, 16, v161
    v_and_b32 v51, 0xffff0000, v161
    v_lshlrev_b32 v52, 16, v162
    v_and_b32 v53, 0xffff0000, v162
    v_lshlrev_b32 v54, 16, v163
    v_and_b32 v55, 0xffff0000, v163
    v_fmac_f32 v32, v48, v24
    v_fmac_f32 v33, v49, v24
    v_fmac_f32 v34, v50, v24
    v_fmac_f32 v35, v51, v24
    v_fmac_f32 v36, v52, v24
    v_fmac_f32 v37, v53, v24
    v_fmac_f32 v38, v54, v24
    v_fmac_f32 v39, v55, v24
    s_barrier
    buffer_load_dwordx4 v[176:179], v108, s[36:39], s55 offen
    s_add_u32 s55, s55, s63
    buffer_load_dwordx4 v[180:183], v108, s[36:39], s55 offen
    s_add_u32 s55, s55, s63
    s_waitcnt vmcnt(4)
    v_lshlrev_b32 v56, 16, v164
    v_and_b32 v57, 0xffff0000, v164
    v_lshlrev_b32 v58, 16, v165
    v_and_b32 v59, 0xffff0000, v165
    v_lshlrev_b32 v60, 16, v166
    v_and_b32 v61, 0xffff0000, v166
    v_lshlrev_b32 v62, 16, v167
    v_and_b32 v63, 0xffff0000, v167
    v_fmac_f32 v32, v56, v25
    v_fmac_f32 v33, v57, v25
    v_fmac_f32 v34, v58, v25
    v_fmac_f32 v35, v59, v25
    v_fmac_f32 v36, v60, v25
    v_fmac_f32 v37, v61, v25
    v_fmac_f32 v38, v62, v25
    v_fmac_f32 v39, v63, v25
    s_barrier
    buffer_load_dwordx4 v[184:187], v108, s[36:39], s55 offen
    s_add_u32 s55, s55, s63
    buffer_load_dwordx4 v[188:191], v108, s[36:39], s55 offen
    s_add_u32 s55, s55, s63
    s_waitcnt vmcnt(5)
    v_lshlrev_b32 v48, 16, v168
    v_and_b32 v49, 0xffff0000, v168
    v_lshlrev_b32 v50, 16, v169
    v_and_b32 v51, 0xffff0000, v169
    v_lshlrev_b32 v52, 16, v170
    v_and_b32 v53, 0xffff0000, v170
    v_lshlrev_b32 v54, 16, v171
    v_and_b32 v55, 0xffff0000, v171
    v_fmac_f32 v32, v48, v26
    v_fmac_f32 v33, v49, v26
    v_fmac_f32 v34, v50, v26
    v_fmac_f32 v35, v51, v26
    v_fmac_f32 v36, v52, v26
    v_fmac_f32 v37, v53, v26
    v_fmac_f32 v38, v54, v26
    v_fmac_f32 v39, v55, v26
    s_waitcnt vmcnt(4)
    v_lshlrev_b32 v56, 16, v172
    v_and_b32 v57, 0xffff0000, v172
    v_lshlrev_b32 v58, 16, v173
    v_and_b32 v59, 0xffff0000, v173
    v_lshlrev_b32 v60, 16, v174
    v_and_b32 v61, 0xffff0000, v174
    v_lshlrev_b32 v62, 16, v175
    v_and_b32 v63, 0xffff0000, v175
    v_fmac_f32 v32, v56, v27
    v_fmac_f32 v33, v57, v27
    v_fmac_f32 v34, v58, v27
    v_fmac_f32 v35, v59, v27
    v_fmac_f32 v36, v60, v27
    v_fmac_f32 v37, v61, v27
    v_fmac_f32 v38, v62, v27
    v_fmac_f32 v39, v63, v27
    s_barrier
    s_waitcnt vmcnt(3)
    v_lshlrev_b32 v48, 16, v176
    v_and_b32 v49, 0xffff0000, v176
    v_lshlrev_b32 v50, 16, v177
    v_and_b32 v51, 0xffff0000, v177
    v_lshlrev_b32 v52, 16, v178
    v_and_b32 v53, 0xffff0000, v178
    v_lshlrev_b32 v54, 16, v179
    v_and_b32 v55, 0xffff0000, v179
    v_fmac_f32 v32, v48, v28
    v_fmac_f32 v33, v49, v28
    v_fmac_f32 v34, v50, v28
    v_fmac_f32 v35, v51, v28
    v_fmac_f32 v36, v52, v28
    v_fmac_f32 v37, v53, v28
    v_fmac_f32 v38, v54, v28
    v_fmac_f32 v39, v55, v28
    s_waitcnt vmcnt(2)
    v_lshlrev_b32 v56, 16, v180
    v_and_b32 v57, 0xffff0000, v180
    v_lshlrev_b32 v58, 16, v181
    v_and_b32 v59, 0xffff0000, v181
    v_lshlrev_b32 v60, 16, v182
    v_and_b32 v61, 0xffff0000, v182
    v_lshlrev_b32 v62, 16, v183
    v_and_b32 v63, 0xffff0000, v183
    v_fmac_f32 v32, v56, v29
    v_fmac_f32 v33, v57, v29
    v_fmac_f32 v34, v58, v29
    v_fmac_f32 v35, v59, v29
    v_fmac_f32 v36, v60, v29
    v_fmac_f32 v37, v61, v29
    v_fmac_f32 v38, v62, v29
    v_fmac_f32 v39, v63, v29
    s_barrier
    s_waitcnt vmcnt(1)
    v_lshlrev_b32 v48, 16, v184
    v_and_b32 v49, 0xffff0000, v184
    v_lshlrev_b32 v50, 16, v185
    v_and_b32 v51, 0xffff0000, v185
    v_lshlrev_b32 v52, 16, v186
    v_and_b32 v53, 0xffff0000, v186
    v_lshlrev_b32 v54, 16, v187
    v_and_b32 v55, 0xffff0000, v187
    v_fmac_f32 v32, v48, v30
    v_fmac_f32 v33, v49, v30
    v_fmac_f32 v34, v50, v30
    v_fmac_f32 v35, v51, v30
    v_fmac_f32 v36, v52, v30
    v_fmac_f32 v37, v53, v30
    v_fmac_f32 v38, v54, v30
    v_fmac_f32 v39, v55, v30
    s_waitcnt vmcnt(0)
    v_lshlrev_b32 v56, 16, v188
    v_and_b32 v57, 0xffff0000, v188
    v_lshlrev_b32 v58, 16, v189
    v_and_b32 v59, 0xffff0000, v189
    v_lshlrev_b32 v60, 16, v190
    v_and_b32 v61, 0xffff0000, v190
    v_lshlrev_b32 v62, 16, v191
    v_and_b32 v63, 0xffff0000, v191
    v_fmac_f32 v32, v56, v31
    v_fmac_f32 v33, v57, v31
    v_fmac_f32 v34, v58, v31
    v_fmac_f32 v35, v59, v31
    v_fmac_f32 v36, v60, v31
    v_fmac_f32 v37, v61, v31
    v_fmac_f32 v38, v62, v31
    v_fmac_f32 v39, v63, v31
    s_nop 3
    v_permlane32_swap_b32 v32, v36
    v_permlane32_swap_b32 v33, v37
    v_permlane32_swap_b32 v34, v38
    v_permlane32_swap_b32 v35, v39
    s_nop 1
    v_add_f32 v32, v32, v36
    v_add_f32 v33, v33, v37
    v_add_f32 v34, v34, v38
    v_add_f32 v35, v35, v39
    s_nop 1
    v_permlane16_swap_b32 v32, v34
    v_permlane16_swap_b32 v33, v35
    s_nop 1
    v_add_f32 v32, v32, v34
    v_add_f32 v33, v33, v35
    s_nop 1
    v_add_f32_dpp v32, v32, v32 row_ror:8 row_mask:0xf bank_mask:0xf
    v_add_f32_dpp v33, v33, v33 row_ror:8 row_mask:0xf bank_mask:0xf
    v_lshrrev_b32 v40, 4, v2
    v_lshlrev_b32 v40, 3, v40
    v_lshl_add_u32 v40, v15, 5, v40
    s_lshl_b32 s56, s60, 8
    s_add_u32 s56, s56, 126080
    v_add_u32 v40, s56, v40
    ds_write_b64 v40, v[32:33]
    v_lshlrev_b32 v41, 2, v2
    v_add_u32 v42, 126080, v41
    s_lshr_b32 s56, s61, 4
    s_lshl_b32 s56, 1, s56
    s_and_b32 s56, s56, 0x12
    s_cselect_b32 s56, 1.0, 0
    s_cmp_eq_u32 s62, 0
    s_cselect_b32 s56, s56, 0
    s_waitcnt lgkmcnt(0)
    s_barrier
    s_cmp_lg_u32 s60, 0
    s_cbranch_scc1 KA_end
    s_cmp_lt_u32 s2, 192
    s_cbranch_scc0 KA_end
    ds_read_b32 v32, v42 offset:0
    ds_read_b32 v33, v42 offset:256
    ds_read_b32 v34, v42 offset:512
    ds_read_b32 v35, v42 offset:768
    s_waitcnt lgkmcnt(0)
    v_add_f32 v32, v32, v33
    v_add_f32 v34, v34, v35
    v_add_f32 v32, v32, v34
    v_add_f32 v32, s56, v32
    buffer_atomic_add_f32 v32, v78, s[16:19], 0 offen
KA_end:
    s_endpgm

.globl km_kernel
.p2align 8
.type km_kernel,@function
km_kernel:
    s_cmp_ge_u32 s2, 256
    s_cbranch_scc1 KM_end
    s_load_dwordx2 s[16:17], s[0:1], 0
    s_load_dwordx2 s[20:21], s[0:1], 120
    s_load_dwordx4 s[4:7], s[0:1], 56
    s_load_dwordx4 s[12:15], s[0:1], 72
    s_load_dwordx2 s[8:9], s[0:1], 104
    v_lshrrev_b32 v1, 6, v0
    v_and_b32 v2, 63, v0
    v_readfirstlane_b32 s3, v1
    s_and_b32 s44, s2, 7
    s_lshr_b32 s45, s2, 3
    s_lshr_b32 s46, s44, 1
    s_lshl_b32 s46, s46, 2
    s_lshr_b32 s47, s45, 3
    s_add_u32 s46, s46, s47
    s_and_b32 s44, s44, 1
    s_and_b32 s45, s45, 7
    s_lshl_b32 s47, s44, 3
    s_add_u32 s47, s47, s45
    s_lshr_b32 s52, s45, 2
    s_lshl_b32 s52, s52, 3
    s_lshl_b32 s53, s44, 2
    s_add_u32 s52, s52, s53
    s_and_b32 s53, s45, 3
    s_add_u32 s52, s52, s53
    s_lshl_b32 s53, s46, 4
    s_add_u32 s53, s52, s53
    s_lshl_b32 s53, s53, 3
    s_add_u32 s53, s53, s3
    s_mul_i32 s54, s53, 2176
    v_lshl_add_u32 v38, v2, 4, s54
    s_lshl_b32 s53, s53, 11
    v_lshl_add_u32 v3, v2, 4, s53
    v_lshrrev_b32 v4, 2, v2
    v_and_b32 v5, 7, v4
    v_lshlrev_b32 v5, 1, v5
    v_lshrrev_b32 v4, 3, v4
    v_add_u32 v5, v5, v4
    v_lshrrev_b32 v6, 3, v5
    v_and_b32 v7, 3, v2
    v_xor_b32 v6, v6, v7
    v_lshrrev_b32 v4, 2, v5
    v_and_b32 v7, 1, v4
    v_mad_u32_u24 v4, v4, 7, v7
    v_and_b32 v5, 3, v5
    v_add_lshl_u32 v5, v5, v4, 10
    s_lshl_b32 s54, s46, 3
    s_add_u32 s54, s54, s3
    s_mul_i32 s54, s54, 114688
    s_lshl_b32 s55, s52, 6
    s_add_u32 s54, s54, s55
    s_add_u32 s54, s54, 20971520
    v_add_u32 v5, s54, v5
    v_lshl_add_u32 v8, v6, 4, v5
    v_xor_b32 v6, 2, v6
    v_lshl_add_u32 v9, v6, 4, v5
    v_lshlrev_b32 v10, 4, v0
    s_mov_b32 s49, 28672
    s_mov_b32 s18, 4194304
    s_mov_b32 s19, 0x20000
    s_mov_b32 s22, 67108864
    s_mov_b32 s23, 0x20000
    s_lshl_b32 s55, s3, 11
    s_add_u32 s55, s55, 90112
    s_lshl_b32 s56, s3, 10
    s_add_u32 s56, s56, 135168
    s_mov_b32 s57, 4456448
    s_mov_b32 s58, 4464640
    s_mov_b32 s59, 4472832
    s_mov_b32 m0, s55
    s_waitcnt lgkmcnt(0)
    buffer_load_dwordx4 v[40:43], v3, s[16:19], 0 offen
    buffer_load_dwordx4 v[44:47], v3, s[16:19], 0 offen offset:1024
    buffer_load_dwordx4 v8, s[20:23], 0 offen lds
    s_add_u32 m0, s55, 1024
    s_mov_b32 s24, s4
    buffer_load_dwordx4 v9, s[20:23], s49 offen lds
    s_mov_b32 m0, s56
    s_mov_b32 s25, s5
    buffer_load_dwordx4 v10, s[20:23], s57 offen lds
    s_add_u32 m0, s56, 8192
    s_mov_b32 s26, 7340032
    buffer_load_dwordx4 v10, s[20:23], s58 offen lds
    s_add_u32 m0, s56, 16384
    s_mov_b32 s27, 0x20000
    s_cmp_ge_u32 s3, 4
    s_cbranch_scc1 KM_m3
    buffer_load_dwordx4 v10, s[20:23], s59 offen lds
KM_m3:
    s_and_b32 s48, s47, 1
    s_mul_i32 s49, s47, 448
    s_lshl_b32 s50, s48, 6
    s_add_u32 s50, s50, s49
    s_cmp_eq_u32 s48, 0
    s_cselect_b32 s51, 384, 0
    s_add_u32 s51, s51, s49
    s_mul_i32 s55, s2, 28672
    v_add_u32 v11, s55, v10
    s_mov_b32 s55, 8192
    s_mov_b32 s56, 16384
    s_mov_b32 s57, 20480
    s_barrier
    buffer_load_dwordx4 v[144:147], v11, s[24:27], 0 offen
    buffer_load_dwordx4 v[148:151], v11, s[24:27], s55 offen
    buffer_load_dwordx4 v[152:155], v11, s[24:27], s56 offen
    buffer_load_dwordx4 v[156:159], v11, s[24:27], s57 offen
    v_mov_b32 v126, 0x3a800000
    v_lshrrev_b32 v4, 3, v2
    v_lshlrev_b32 v4, 10, v4
    v_and_b32 v5, 7, v2
    v_lshl_add_u32 v4, v5, 6, v4
    v_bfe_u32 v5, v2, 2, 2
    s_lshr_b32 s56, s3, 1
    v_xor_b32 v5, s56, v5
    v_lshl_add_u32 v4, v5, 4, v4
    s_and_b32 s56, s3, 1
    s_lshl_b32 s56, s56, 3
    s_add_u32 s56, s56, 90112
    v_add_u32 v4, s56, v4
    v_lshlrev_b32 v5, 4, v2
    v_add_u32 v5, 135168, v5
    s_mov_b32 s58, 5242880
    s_mov_b32 s59, 12582912
    s_waitcnt vmcnt(8)
    v_lshlrev_b32 v48, 16, v40
    v_and_b32 v49, 0xffff0000, v40
    v_lshlrev_b32 v50, 16, v41
    v_and_b32 v51, 0xffff0000, v41
    v_lshlrev_b32 v52, 16, v42
    v_and_b32 v53, 0xffff0000, v42
    v_lshlrev_b32 v54, 16, v43
    v_and_b32 v55, 0xffff0000, v43
    v_lshlrev_b32 v56, 16, v44
    v_and_b32 v57, 0xffff0000, v44
    v_lshlrev_b32 v58, 16, v45
    v_and_b32 v59, 0xffff0000, v45
    v_lshlrev_b32 v60, 16, v46
    v_and_b32 v61, 0xffff0000, v46
    v_lshlrev_b32 v62, 16, v47
    v_and_b32 v63, 0xffff0000, v47
    v_pk_add_f32 v[6:7], v[48:49], v[50:51]
    v_pk_mul_f32 v[8:9], v[48:49], v[48:49]
    v_pk_fma_f32 v[8:9], v[50:51], v[50:51], v[8:9]
    v_pk_add_f32 v[6:7], v[6:7], v[52:53]
    v_pk_fma_f32 v[8:9], v[52:53], v[52:53], v[8:9]
    v_pk_add_f32 v[6:7], v[6:7], v[54:55]
    v_pk_fma_f32 v[8:9], v[54:55], v[54:55], v[8:9]
    v_pk_add_f32 v[6:7], v[6:7], v[56:57]
    v_pk_fma_f32 v[8:9], v[56:57], v[56:57], v[8:9]
    v_pk_add_f32 v[6:7], v[6:7], v[58:59]
    v_pk_fma_f32 v[8:9], v[58:59], v[58:59], v[8:9]
    v_pk_add_f32 v[6:7], v[6:7], v[60:61]
    v_pk_fma_f32 v[8:9], v[60:61], v[60:61], v[8:9]
    v_pk_add_f32 v[6:7], v[6:7], v[62:63]
    v_pk_fma_f32 v[8:9], v[62:63], v[62:63], v[8:9]
    v_add_f32 v6, v6, v7
    v_add_f32 v8, v8, v9
    s_nop 0
    v_add_f32_dpp v6, v6, v6 quad_perm:[1,0,3,2] row_mask:0xf bank_mask:0xf
    v_add_f32_dpp v8, v8, v8 quad_perm:[1,0,3,2] row_mask:0xf bank_mask:0xf
    s_nop 0
    v_add_f32_dpp v6, v6, v6 quad_perm:[2,3,0,1] row_mask:0xf bank_mask:0xf
    v_add_f32_dpp v8, v8, v8 quad_perm:[2,3,0,1] row_mask:0xf bank_mask:0xf
    s_nop 0
    v_add_f32_dpp v6, v6, v6 row_half_mirror row_mask:0xf bank_mask:0xf
    v_add_f32_dpp v8, v8, v8 row_half_mirror row_mask:0xf bank_mask:0xf
    s_nop 0
    v_add_f32_dpp v6, v6, v6 row_mirror row_mask:0xf bank_mask:0xf
    v_add_f32_dpp v8, v8, v8 row_mirror row_mask:0xf bank_mask:0xf
    s_nop 0
    v_add_f32_dpp v6, v6, v6 row_bcast:15 row_mask:0xa bank_mask:0xf
    v_add_f32_dpp v8, v8, v8 row_bcast:15 row_mask:0xa bank_mask:0xf
    s_nop 0
    v_add_f32_dpp v6, v6, v6 row_bcast:31 row_mask:0xc bank_mask:0xf
    v_add_f32_dpp v8, v8, v8 row_bcast:31 row_mask:0xc bank_mask:0xf
    s_nop 0
    v_readlane_b32 s60, v6, 63
    v_readlane_b32 s61, v8, 63
    s_nop 0
    v_mul_f32 v10, s60, v126
    v_mul_f32 v12, s61, v126
    v_fma_f32 v12, -v10, v10, v12
    v_max_f32 v12, 0, v12
    v_add_f32 v12, 0x3727c5ac, v12
    v_rsq_f32 v12, v12
    s_nop 0
    v_mul_f32_e64 v13, -v10, v12
    v_pk_fma_f32 v[80:81], v[48:49], v[12:13], v[12:13] op_sel:[0,0,1] op_sel_hi:[1,0,1]
    v_pk_fma_f32 v[82:83], v[50:51], v[12:13], v[12:13] op_sel:[0,0,1] op_sel_hi:[1,0,1]
    v_pk_fma_f32 v[84:85], v[52:53], v[12:13], v[12:13] op_sel:[0,0,1] op_sel_hi:[1,0,1]
    v_pk_fma_f32 v[86:87], v[54:55], v[12:13], v[12:13] op_sel:[0,0,1] op_sel_hi:[1,0,1]
    v_pk_fma_f32 v[88:89], v[56:57], v[12:13], v[12:13] op_sel:[0,0,1] op_sel_hi:[1,0,1]
    v_pk_fma_f32 v[90:91], v[58:59], v[12:13], v[12:13] op_sel:[0,0,1] op_sel_hi:[1,0,1]
    v_pk_fma_f32 v[92:93], v[60:61], v[12:13], v[12:13] op_sel:[0,0,1] op_sel_hi:[1,0,1]
    v_pk_fma_f32 v[94:95], v[62:63], v[12:13], v[12:13] op_sel:[0,0,1] op_sel_hi:[1,0,1]
    s_waitcnt vmcnt(4)
    s_barrier
    ds_read_b128 v[16:19], v5 offset:4096
    ds_read_b128 v[20:23], v5 offset:5120
    ds_read_b128 v[24:27], v5 offset:6144
    ds_read_b128 v[28:31], v5 offset:7168
    ds_read_b128 v[96:99], v5 offset:0
    ds_read_b128 v[100:103], v5 offset:1024
    ds_read_b128 v[104:107], v5 offset:2048
    ds_read_b128 v[108:111], v5 offset:3072
    ds_read_b64 v[40:41], v4 offset:0
    ds_read_b64 v[42:43], v4 offset:512
    ds_read_b64 v[44:45], v4 offset:8192
    ds_read_b64 v[46:47], v4 offset:8704
    s_waitcnt lgkmcnt(4)
    ds_read_b128 v[128:131], v5 offset:8192
    ds_read_b128 v[132:135], v5 offset:9216
    ds_read_b128 v[136:139], v5 offset:10240
    ds_read_b128 v[140:143], v5 offset:11264
    v_pk_fma_f32 v[80:81], v[80:81], v[16:17], v[96:97]
    v_pk_fma_f32 v[82:83], v[82:83], v[18:19], v[98:99]
    v_pk_fma_f32 v[84:85], v[84:85], v[20:21], v[100:101]
    v_pk_fma_f32 v[86:87], v[86:87], v[22:23], v[102:103]
    v_pk_fma_f32 v[88:89], v[88:89], v[24:25], v[104:105]
    v_pk_fma_f32 v[90:91], v[90:91], v[26:27], v[106:107]
    v_pk_fma_f32 v[92:93], v[92:93], v[28:29], v[108:109]
    v_pk_fma_f32 v[94:95], v[94:95], v[30:31], v[110:111]
    s_waitcnt lgkmcnt(4)
    ds_read_b128 v[16:19], v5 offset:16384
    ds_read_b128 v[20:23], v5 offset:17408
    ds_read_b128 v[24:27], v5 offset:18432
    ds_read_b128 v[28:31], v5 offset:19456
    ds_read_b128 v[96:99], v5 offset:12288
    ds_read_b128 v[100:103], v5 offset:13312
    ds_read_b128 v[104:107], v5 offset:14336
    ds_read_b128 v[108:111], v5 offset:15360
    v_lshlrev_b32 v64, 16, v40
    v_and_b32 v65, 0xffff0000, v40
    v_lshlrev_b32 v66, 16, v41
    v_and_b32 v67, 0xffff0000, v41
    v_lshlrev_b32 v68, 16, v42
    v_and_b32 v69, 0xffff0000, v42
    v_lshlrev_b32 v70, 16, v43
    v_and_b32 v71, 0xffff0000, v43
    v_lshlrev_b32 v72, 16, v44
    v_and_b32 v73, 0xffff0000, v44
    v_lshlrev_b32 v74, 16, v45
    v_and_b32 v75, 0xffff0000, v45
    v_lshlrev_b32 v76, 16, v46
    v_and_b32 v77, 0xffff0000, v46
    v_lshlrev_b32 v78, 16, v47
    v_and_b32 v79, 0xffff0000, v47
    v_pk_mul_f32 v[80:81], v[80:81], v[64:65]
    v_pk_mul_f32 v[82:83], v[82:83], v[66:67]
    v_pk_mul_f32 v[84:85], v[84:85], v[68:69]
    v_pk_mul_f32 v[86:87], v[86:87], v[70:71]
    v_pk_mul_f32 v[88:89], v[88:89], v[72:73]
    v_pk_mul_f32 v[90:91], v[90:91], v[74:75]
    v_pk_mul_f32 v[92:93], v[92:93], v[76:77]
    v_pk_mul_f32 v[94:95], v[94:95], v[78:79]
    s_waitcnt lgkmcnt(8)
    v_pk_fma_f32 v[48:49], v[80:81], v[128:129], v[48:49]
    v_pk_fma_f32 v[50:51], v[82:83], v[130:131], v[50:51]
    v_pk_fma_f32 v[52:53], v[84:85], v[132:133], v[52:53]
    v_pk_fma_f32 v[54:55], v[86:87], v[134:135], v[54:55]
    v_pk_fma_f32 v[56:57], v[88:89], v[136:137], v[56:57]
    v_pk_fma_f32 v[58:59], v[90:91], v[138:139], v[58:59]
    v_pk_fma_f32 v[60:61], v[92:93], v[140:141], v[60:61]
    v_pk_fma_f32 v[62:63], v[94:95], v[142:143], v[62:63]
    v_pk_add_f32 v[6:7], v[48:49], v[50:51]
    v_pk_mul_f32 v[8:9], v[48:49], v[48:49]
    v_pk_fma_f32 v[8:9], v[50:51], v[50:51], v[8:9]
    v_pk_add_f32 v[6:7], v[6:7], v[52:53]
    v_pk_fma_f32 v[8:9], v[52:53], v[52:53], v[8:9]
    v_pk_add_f32 v[6:7], v[6:7], v[54:55]
    v_pk_fma_f32 v[8:9], v[54:55], v[54:55], v[8:9]
    v_pk_add_f32 v[6:7], v[6:7], v[56:57]
    v_pk_fma_f32 v[8:9], v[56:57], v[56:57], v[8:9]
    v_pk_add_f32 v[6:7], v[6:7], v[58:59]
    v_pk_fma_f32 v[8:9], v[58:59], v[58:59], v[8:9]
    v_pk_add_f32 v[6:7], v[6:7], v[60:61]
    v_pk_fma_f32 v[8:9], v[60:61], v[60:61], v[8:9]
    v_pk_add_f32 v[6:7], v[6:7], v[62:63]
    v_pk_fma_f32 v[8:9], v[62:63], v[62:63], v[8:9]
    v_add_f32 v6, v6, v7
    v_add_f32 v8, v8, v9
    s_nop 0
    v_add_f32_dpp v6, v6, v6 quad_perm:[1,0,3,2] row_mask:0xf bank_mask:0xf
    v_add_f32_dpp v8, v8, v8 quad_perm:[1,0,3,2] row_mask:0xf bank_mask:0xf
    s_nop 0
    v_add_f32_dpp v6, v6, v6 quad_perm:[2,3,0,1] row_mask:0xf bank_mask:0xf
    v_add_f32_dpp v8, v8, v8 quad_perm:[2,3,0,1] row_mask:0xf bank_mask:0xf
    s_nop 0
    v_add_f32_dpp v6, v6, v6 row_half_mirror row_mask:0xf bank_mask:0xf
    v_add_f32_dpp v8, v8, v8 row_half_mirror row_mask:0xf bank_mask:0xf
    s_nop 0
    v_add_f32_dpp v6, v6, v6 row_mirror row_mask:0xf bank_mask:0xf
    v_add_f32_dpp v8, v8, v8 row_mirror row_mask:0xf bank_mask:0xf
    s_nop 0
    v_add_f32_dpp v6, v6, v6 row_bcast:15 row_mask:0xa bank_mask:0xf
    v_add_f32_dpp v8, v8, v8 row_bcast:15 row_mask:0xa bank_mask:0xf
    s_nop 0
    v_add_f32_dpp v6, v6, v6 row_bcast:31 row_mask:0xc bank_mask:0xf
    v_add_f32_dpp v8, v8, v8 row_bcast:31 row_mask:0xc bank_mask:0xf
    s_nop 0
    v_readlane_b32 s60, v6, 63
    v_readlane_b32 s61, v8, 63
    s_nop 0
    v_mul_f32 v10, s60, v126
    v_mul_f32 v12, s61, v126
    v_fma_f32 v12, -v10, v10, v12
    v_max_f32 v12, 0, v12
    v_add_f32 v12, 0x3727c5ac, v12
    v_rsq_f32 v12, v12
    s_nop 0
    v_mul_f32_e64 v13, -v10, v12
    v_pk_fma_f32 v[80:81], v[48:49], v[12:13], v[12:13] op_sel:[0,0,1] op_sel_hi:[1,0,1]
    v_pk_fma_f32 v[82:83], v[50:51], v[12:13], v[12:13] op_sel:[0,0,1] op_sel_hi:[1,0,1]
    v_pk_fma_f32 v[84:85], v[52:53], v[12:13], v[12:13] op_sel:[0,0,1] op_sel_hi:[1,0,1]
    v_pk_fma_f32 v[86:87], v[54:55], v[12:13], v[12:13] op_sel:[0,0,1] op_sel_hi:[1,0,1]
    v_pk_fma_f32 v[88:89], v[56:57], v[12:13], v[12:13] op_sel:[0,0,1] op_sel_hi:[1,0,1]
    v_pk_fma_f32 v[90:91], v[58:59], v[12:13], v[12:13] op_sel:[0,0,1] op_sel_hi:[1,0,1]
    v_pk_fma_f32 v[92:93], v[60:61], v[12:13], v[12:13] op_sel:[0,0,1] op_sel_hi:[1,0,1]
    v_pk_fma_f32 v[94:95], v[62:63], v[12:13], v[12:13] op_sel:[0,0,1] op_sel_hi:[1,0,1]
    s_waitcnt lgkmcnt(0)
    v_pk_fma_f32 v[80:81], v[80:81], v[16:17], v[96:97]
    v_pk_fma_f32 v[82:83], v[82:83], v[18:19], v[98:99]
    v_pk_fma_f32 v[84:85], v[84:85], v[20:21], v[100:101]
    v_pk_fma_f32 v[86:87], v[86:87], v[22:23], v[102:103]
    v_pk_fma_f32 v[88:89], v[88:89], v[24:25], v[104:105]
    v_pk_fma_f32 v[90:91], v[90:91], v[26:27], v[106:107]
    v_pk_fma_f32 v[92:93], v[92:93], v[28:29], v[108:109]
    v_pk_fma_f32 v[94:95], v[94:95], v[30:31], v[110:111]
    v_pk_add_f32 v[6:7], v[80:81], v[82:83]
    v_pk_mul_f32 v[8:9], v[80:81], v[80:81]
    v_pk_fma_f32 v[8:9], v[82:83], v[82:83], v[8:9]
    v_pk_add_f32 v[6:7], v[6:7], v[84:85]
    v_pk_fma_f32 v[8:9], v[84:85], v[84:85], v[8:9]
    v_pk_add_f32 v[6:7], v[6:7], v[86:87]
    v_pk_fma_f32 v[8:9], v[86:87], v[86:87], v[8:9]
    v_pk_add_f32 v[6:7], v[6:7], v[88:89]
    v_pk_fma_f32 v[8:9], v[88:89], v[88:89], v[8:9]
    v_pk_add_f32 v[6:7], v[6:7], v[90:91]
    v_pk_fma_f32 v[8:9], v[90:91], v[90:91], v[8:9]
    v_pk_add_f32 v[6:7], v[6:7], v[92:93]
    v_pk_fma_f32 v[8:9], v[92:93], v[92:93], v[8:9]
    v_pk_add_f32 v[6:7], v[6:7], v[94:95]
    v_pk_fma_f32 v[8:9], v[94:95], v[94:95], v[8:9]
    v_add_f32 v6, v6, v7
    v_add_f32 v8, v8, v9
    s_nop 0
    v_add_f32_dpp v6, v6, v6 quad_perm:[1,0,3,2] row_mask:0xf bank_mask:0xf
    v_add_f32_dpp v8, v8, v8 quad_perm:[1,0,3,2] row_mask:0xf bank_mask:0xf
    s_nop 0
    v_add_f32_dpp v6, v6, v6 quad_perm:[2,3,0,1] row_mask:0xf bank_mask:0xf
    v_add_f32_dpp v8, v8, v8 quad_perm:[2,3,0,1] row_mask:0xf bank_mask:0xf
    s_nop 0
    v_add_f32_dpp v6, v6, v6 row_half_mirror row_mask:0xf bank_mask:0xf
    v_add_f32_dpp v8, v8, v8 row_half_mirror row_mask:0xf bank_mask:0xf
    s_nop 0
    v_add_f32_dpp v6, v6, v6 row_mirror row_mask:0xf bank_mask:0xf
    v_add_f32_dpp v8, v8, v8 row_mirror row_mask:0xf bank_mask:0xf
    s_nop 0
    v_add_f32_dpp v6, v6, v6 row_bcast:15 row_mask:0xa bank_mask:0xf
    v_add_f32_dpp v8, v8, v8 row_bcast:15 row_mask:0xa bank_mask:0xf
    s_nop 0
    v_add_f32_dpp v6, v6, v6 row_bcast:31 row_mask:0xc bank_mask:0xf
    v_add_f32_dpp v8, v8, v8 row_bcast:31 row_mask:0xc bank_mask:0xf
    s_nop 0
    v_readlane_b32 s60, v6, 63
    v_readlane_b32 s61, v8, 63
    s_nop 0
    v_mul_f32 v10, s60, v126
    v_mul_f32 v12, s61, v126
    v_fma_f32 v12, -v10, v10, v12
    v_max_f32 v12, 0, v12
    v_add_f32 v12, 0x3727c5ac, v12
    v_rsq_f32 v12, v12
    s_nop 0
    v_mul_f32_e64 v13, -v10, v12
    v_pk_fma_f32 v[80:81], v[80:81], v[12:13], v[12:13] op_sel:[0,0,1] op_sel_hi:[1,0,1]
    v_pk_fma_f32 v[82:83], v[82:83], v[12:13], v[12:13] op_sel:[0,0,1] op_sel_hi:[1,0,1]
    v_pk_fma_f32 v[84:85], v[84:85], v[12:13], v[12:13] op_sel:[0,0,1] op_sel_hi:[1,0,1]
    v_pk_fma_f32 v[86:87], v[86:87], v[12:13], v[12:13] op_sel:[0,0,1] op_sel_hi:[1,0,1]
    v_pk_fma_f32 v[88:89], v[88:89], v[12:13], v[12:13] op_sel:[0,0,1] op_sel_hi:[1,0,1]
    v_pk_fma_f32 v[90:91], v[90:91], v[12:13], v[12:13] op_sel:[0,0,1] op_sel_hi:[1,0,1]
    v_pk_fma_f32 v[92:93], v[92:93], v[12:13], v[12:13] op_sel:[0,0,1] op_sel_hi:[1,0,1]
    v_pk_fma_f32 v[94:95], v[94:95], v[12:13], v[12:13] op_sel:[0,0,1] op_sel_hi:[1,0,1]
    v_cvt_pk_bf16_f32 v64, v80, v81
    v_cvt_pk_bf16_f32 v65, v82, v83
    v_cvt_pk_bf16_f32 v66, v84, v85
    v_cvt_pk_bf16_f32 v67, v86, v87
    buffer_store_dwordx4 v[64:67], v38, s[20:23], s58 offen offset:0 sc1
    v_cvt_pk_bf16_f32 v68, v88, v89
    v_cvt_pk_bf16_f32 v69, v90, v91
    v_cvt_pk_bf16_f32 v70, v92, v93
    v_cvt_pk_bf16_f32 v71, v94, v95
    buffer_store_dwordx4 v[68:71], v38, s[20:23], s58 offen offset:1024 sc1
    v_cvt_pk_bf16_f32 v40, v48, v49
    v_cvt_pk_bf16_f32 v41, v50, v51
    v_cvt_pk_bf16_f32 v42, v52, v53
    v_cvt_pk_bf16_f32 v43, v54, v55
    v_cvt_pk_bf16_f32 v44, v56, v57
    v_cvt_pk_bf16_f32 v45, v58, v59
    v_cvt_pk_bf16_f32 v46, v60, v61
    v_cvt_pk_bf16_f32 v47, v62, v63
    v_add_u32 v39, 12582912, v3
    s_cmp_ge_u32 s3, 4
    s_cbranch_scc0 KM_compute
    s_sub_u32 s3, s3, 4
    v_lshrrev_b32 v3, 3, v2
    v_and_b32 v4, 7, v2
    v_bfe_u32 v5, v2, 4, 1
    v_lshlrev_b32 v5, 1, v5
    v_xor_b32 v5, v5, v4
    s_lshl_b32 s53, s3, 4
    v_add_u32 v6, s53, v3
    v_mul_u32_u24 v6, 7168, v6
    v_add_u32 v6, s50, v6
    v_lshl_add_u32 v12, v5, 4, v6
    v_xor_b32 v5, 4, v5
    v_lshl_add_u32 v13, v5, 4, v6
    v_add_u32 v13, 57344, v13
    v_lshrrev_b32 v6, 2, v2
    v_add_u32 v6, s53, v6
    v_mul_u32_u24 v6, 7168, v6
    v_add_u32 v6, s51, v6
    v_lshrrev_b32 v5, 5, v2
    v_lshlrev_b32 v5, 1, v5
    v_and_b32 v7, 3, v2
    v_xor_b32 v5, v5, v7
    v_lshl_add_u32 v14, v5, 4, v6
    s_lshl_b32 s54, s3, 12
    s_lshl_b32 s55, s3, 11
    s_add_u32 s55, s55, 16384
    s_lshl_b32 s56, s3, 10
    s_add_u32 s56, s56, 40960
    s_mov_b32 s57, 0
    s_mov_b32 s58, 0
    s_mov_b32 s59, 0
    s_add_u32 s60, s55, s57
    s_add_u32 s62, s59, 128
    s_add_u32 s63, s59, 256
    s_mov_b32 m0, s60
    s_nop 0
    buffer_load_dwordx4 v12, s[24:27], s59 offen lds
    s_add_u32 m0, s60, 1024
    s_add_u32 s64, s54, s57
    buffer_load_dwordx4 v13, s[24:27], s59 offen lds
    s_add_u32 m0, s60, 8192
    s_add_u32 s52, s58, 34816
    buffer_load_dwordx4 v12, s[24:27], s62 offen lds
    s_add_u32 m0, s60, 9216
    s_nop 0
    buffer_load_dwordx4 v13, s[24:27], s62 offen lds
    s_add_u32 m0, s60, 16384
    s_nop 0
    buffer_load_dwordx4 v12, s[24:27], s63 offen lds
    s_add_u32 m0, s60, 17408
    s_nop 0
    buffer_load_dwordx4 v13, s[24:27], s63 offen lds
    s_add_u32 m0, s56, s57
    s_add_u32 s57, s57, 45056
    buffer_load_dwordx4 v14, s[24:27], s59 offen lds
    s_cmp_eq_u32 s57, 135168
    s_cselect_b32 s57, 0, s57
    s_add_u32 s59, s59, 458752
    s_waitcnt vmcnt(7)
    s_barrier
    buffer_store_dwordx4 v[40:43], v39, s[20:23], 0 offen offset:0 sc1
    buffer_store_dwordx4 v[44:47], v39, s[20:23], 0 offen offset:1024 sc1
    s_add_u32 s60, s55, s57
    s_add_u32 s62, s59, 128
    s_add_u32 s63, s59, 256
    s_mov_b32 m0, s60
    s_nop 0
    buffer_load_dwordx4 v12, s[24:27], s59 offen lds
    s_add_u32 m0, s60, 1024
    s_add_u32 s64, s54, s57
    buffer_load_dwordx4 v13, s[24:27], s59 offen lds
    s_add_u32 m0, s60, 8192
    s_add_u32 s52, s58, 34816
    buffer_load_dwordx4 v12, s[24:27], s62 offen lds
    s_add_u32 m0, s60, 9216
    s_nop 0
    buffer_load_dwordx4 v13, s[24:27], s62 offen lds
    s_add_u32 m0, s60, 16384
    s_nop 0
    buffer_load_dwordx4 v12, s[24:27], s63 offen lds
    s_add_u32 m0, s60, 17408
    s_nop 0
    buffer_load_dwordx4 v13, s[24:27], s63 offen lds
    s_add_u32 m0, s56, s57
    s_add_u32 s57, s57, 45056
    buffer_load_dwordx4 v14, s[24:27], s59 offen lds
    s_cmp_eq_u32 s57, 135168
    s_cselect_b32 s57, 0, s57
    s_add_u32 s59, s59, 458752
    v_lshrrev_b32 v5, 4, v2
    v_xor_b32 v5, v5, v4
    s_lshl_b32 s52, s46, 7
    s_lshl_b32 s53, s3, 5
    s_add_u32 s52, s52, s53
    v_add_u32 v6, s52, v3
    v_mul_u32_u24 v6, 2176, v6
    v_add_u32 v6, 5242880, v6
    v_lshl_add_u32 v10, v5, 4, v6
    v_xor_b32 v5, 4, v5
    v_lshl_add_u32 v11, v5, 4, v6
    v_add_u32 v11, 17408, v11
    s_lshl_b32 s52, s46, 11
    s_add_u32 s52, s52, 52428800
    v_and_b32 v5, 15, v2
    v_lshl_add_u32 v24, v5, 7, s52
    s_mov_b32 s72, 0
KM_rpoll:
    buffer_load_dword v27, v24, s[20:23], 0 offen sc1
    s_add_u32 s72, s72, 1
    s_cmp_gt_u32 s72, 65536
    s_cbranch_scc1 KM_rpoll_x
    s_waitcnt vmcnt(0)
    v_cmp_ne_u32 vcc, 1, v27
    s_cbranch_vccnz KM_rpoll
KM_rpoll_x:
    s_add_u32 s64, s54, 0
    s_add_u32 s52, s58, 34816
    s_add_u32 m0, s64, 0
    s_nop 0
    buffer_load_dwordx4 v10, s[20:23], s58 offen sc1 lds
    s_add_u32 m0, s64, 1024
    s_nop 0
    buffer_load_dwordx4 v11, s[20:23], s58 offen sc1 lds
    s_add_u32 m0, s64, 2048
    s_nop 0
    buffer_load_dwordx4 v10, s[20:23], s52 offen sc1 lds
    s_add_u32 m0, s64, 3072
    s_nop 0
    buffer_load_dwordx4 v11, s[20:23], s52 offen sc1 lds
    s_add_u32 s58, s58, 128
    s_add_u32 s64, s54, 45056
    s_add_u32 s52, s58, 34816
    s_add_u32 m0, s64, 0
    s_nop 0
    buffer_load_dwordx4 v10, s[20:23], s58 offen sc1 lds
    s_add_u32 m0, s64, 1024
    s_nop 0
    buffer_load_dwordx4 v11, s[20:23], s58 offen sc1 lds
    s_add_u32 m0, s64, 2048
    s_nop 0
    buffer_load_dwordx4 v10, s[20:23], s52 offen sc1 lds
    s_add_u32 m0, s64, 3072
    s_nop 0
    buffer_load_dwordx4 v11, s[20:23], s52 offen sc1 lds
    s_add_u32 s58, s58, 128
    s_mov_b32 s28, s12
    s_mov_b32 s29, s13
    s_mov_b32 s30, 7340032
    s_mov_b32 s31, 0x20000
    s_waitcnt vmcnt(4)
    s_barrier
    s_add_u32 s60, s55, s57
    s_add_u32 s62, s59, 128
    s_add_u32 s63, s59, 256
    s_mov_b32 m0, s60
    s_nop 0
    buffer_load_dwordx4 v12, s[24:27], s59 offen lds
    s_add_u32 m0, s60, 1024
    s_add_u32 s64, s54, s57
    buffer_load_dwordx4 v13, s[24:27], s59 offen lds
    s_add_u32 m0, s60, 8192
    s_add_u32 s52, s58, 34816
    buffer_load_dwordx4 v12, s[24:27], s62 offen lds
    s_add_u32 m0, s60, 9216
    s_nop 0
    buffer_load_dwordx4 v13, s[24:27], s62 offen lds
    s_add_u32 m0, s60, 16384
    s_nop 0
    buffer_load_dwordx4 v12, s[24:27], s63 offen lds
    s_add_u32 m0, s60, 17408
    s_nop 0
    buffer_load_dwordx4 v13, s[24:27], s63 offen lds
    s_add_u32 m0, s56, s57
    s_add_u32 s57, s57, 45056
    buffer_load_dwordx4 v14, s[24:27], s59 offen lds
    s_cmp_eq_u32 s57, 135168
    s_cselect_b32 s57, 0, s57
    s_add_u32 s59, s59, 458752
    s_add_u32 s64, s54, 90112
    s_add_u32 s52, s58, 34816
    s_add_u32 m0, s64, 0
    s_nop 0
    buffer_load_dwordx4 v10, s[20:23], s58 offen sc1 lds
    s_add_u32 m0, s64, 1024
    s_nop 0
    buffer_load_dwordx4 v11, s[20:23], s58 offen sc1 lds
    s_add_u32 m0, s64, 2048
    s_nop 0
    buffer_load_dwordx4 v10, s[20:23], s52 offen sc1 lds
    s_add_u32 m0, s64, 3072
    s_nop 0
    buffer_load_dwordx4 v11, s[20:23], s52 offen sc1 lds
    s_add_u32 s58, s58, 128
    s_mul_i32 s52, s2, 28672
    s_mul_i32 s64, s3, 7168
    s_add_u32 s52, s52, s64
    v_lshl_add_u32 v15, v2, 4, s52
    s_lshr_b32 s74, s2, 3
    s_and_b32 s74, s74, 3
    s_add_u32 s74, s74, 3
    s_mov_b32 s73, 0
    s_add_u32 s60, s55, s57
    s_add_u32 s62, s59, 128
    s_add_u32 s63, s59, 256
    s_mov_b32 m0, s60
    s_waitcnt vmcnt(11)
    s_barrier
    buffer_load_dwordx4 v12, s[24:27], s59 offen lds
    s_add_u32 m0, s60, 1024
    s_add_u32 s64, s54, s57
    buffer_load_dwordx4 v13, s[24:27], s59 offen lds
    s_add_u32 m0, s60, 8192
    s_add_u32 s52, s58, 34816
    buffer_load_dwordx4 v12, s[24:27], s62 offen lds
    s_add_u32 m0, s60, 9216
    s_nop 0
    buffer_load_dwordx4 v13, s[24:27], s62 offen lds
    s_add_u32 m0, s60, 16384
    s_nop 0
    buffer_load_dwordx4 v12, s[24:27], s63 offen lds
    s_add_u32 m0, s60, 17408
    s_nop 0
    buffer_load_dwordx4 v13, s[24:27], s63 offen lds
    s_add_u32 m0, s56, s57
    s_add_u32 s57, s57, 45056
    buffer_load_dwordx4 v14, s[24:27], s59 offen lds
    s_cmp_eq_u32 s57, 135168
    s_cselect_b32 s57, 0, s57
    s_add_u32 s59, s59, 458752
    s_add_u32 m0, s64, 0
    s_nop 0
    buffer_load_dwordx4 v10, s[20:23], s58 offen sc1 lds
    s_add_u32 m0, s64, 1024
    s_nop 0
    buffer_load_dwordx4 v11, s[20:23], s58 offen sc1 lds
    s_add_u32 m0, s64, 2048
    s_nop 0
    buffer_load_dwordx4 v10, s[20:23], s52 offen sc1 lds
    s_add_u32 m0, s64, 3072
    s_nop 0
    buffer_load_dwordx4 v11, s[20:23], s52 offen sc1 lds
    s_add_u32 s58, s58, 128
    s_mov_b32 s61, 1
KM_lloop:
    s_add_u32 s60, s55, s57
    s_add_u32 s62, s59, 128
    s_add_u32 s63, s59, 256
    s_mov_b32 m0, s60
    s_waitcnt vmcnt(11)
    s_barrier
    buffer_load_dwordx4 v12, s[24:27], s59 offen lds
    s_add_u32 m0, s60, 1024
    s_add_u32 s64, s54, s57
    buffer_load_dwordx4 v13, s[24:27], s59 offen lds
    s_add_u32 m0, s60, 8192
    s_add_u32 s52, s58, 34816
    buffer_load_dwordx4 v12, s[24:27], s62 offen lds
    s_add_u32 m0, s60, 9216
    s_nop 0
    buffer_load_dwordx4 v13, s[24:27], s62 offen lds
    s_add_u32 m0, s60, 16384
    s_nop 0
    buffer_load_dwordx4 v12, s[24:27], s63 offen lds
    s_add_u32 m0, s60, 17408
    s_nop 0
    buffer_load_dwordx4 v13, s[24:27], s63 offen lds
    s_add_u32 m0, s56, s57
    s_add_u32 s57, s57, 45056
    buffer_load_dwordx4 v14, s[24:27], s59 offen lds
    s_cmp_eq_u32 s57, 135168
    s_cselect_b32 s57, 0, s57
    s_add_u32 s59, s59, 458752
    s_add_u32 m0, s64, 0
    s_nop 0
    buffer_load_dwordx4 v10, s[20:23], s58 offen sc1 lds
    s_add_u32 m0, s64, 1024
    s_nop 0
    buffer_load_dwordx4 v11, s[20:23], s58 offen sc1 lds
    s_add_u32 m0, s64, 2048
    s_nop 0
    buffer_load_dwordx4 v10, s[20:23], s52 offen sc1 lds
    s_add_u32 m0, s64, 3072
    s_nop 0
    buffer_load_dwordx4 v11, s[20:23], s52 offen sc1 lds
    s_add_u32 s58, s58, 128
    s_cmp_lg_u32 s61, 10
    s_cbranch_scc1 KM_nocp
    s_getpc_b64 s[70:71]
KM_pcref:
    s_lshr_b32 s52, s2, 3
    s_lshl_b32 s52, s52, 2
    s_add_u32 s52, s52, s3
    s_lshl_b32 s52, s52, 6
    s_add_u32 s70, s70, s52
    s_addc_u32 s71, s71, 0
    s_load_dword s72, s[70:71], 0
    s_mov_b32 s52, KM_gelu-KM_pcref
    s_load_dword s72, s[70:71], s52
KM_nocp:
    s_add_u32 s61, s61, 1
    s_cmp_lt_u32 s61, 13
    s_cbranch_scc1 KM_lloop
    s_waitcnt vmcnt(11)
    s_barrier
    s_mov_b32 s52, 4096
    buffer_load_dwordx4 v[96:99], v15, s[28:31], 0 offen offset:0
    buffer_load_dwordx4 v[100:103], v15, s[28:31], 0 offen offset:1024
    buffer_load_dwordx4 v[104:107], v15, s[28:31], 0 offen offset:2048
    buffer_load_dwordx4 v[108:111], v15, s[28:31], 0 offen offset:3072
    buffer_load_dwordx4 v[112:115], v15, s[28:31], s52 offen offset:0
    buffer_load_dwordx4 v[116:119], v15, s[28:31], s52 offen offset:1024
    buffer_load_dwordx4 v[120:123], v15, s[28:31], s52 offen offset:2048
    s_waitcnt vmcnt(7)
    s_barrier
    s_lshl_b32 s52, s46, 3
    s_and_b32 s53, s3, 1
    s_lshl_b32 s64, s53, 2
    s_add_u32 s52, s52, s64
    s_mul_i32 s52, s52, 112
    s_mul_i32 s64, s44, 56
    s_add_u32 s52, s52, s64
    s_lshl_b32 s52, s52, 10
    s_add_u32 s52, s52, 20971520
    v_lshl_add_u32 v16, v2, 4, s52
    v_add_u32 v17, 114688, v16
    v_add_u32 v18, 229376, v16
    v_add_u32 v19, 344064, v16
    v_lshrrev_b32 v5, 4, v2
    v_lshlrev_b32 v5, 1, v5
    v_xor_b32 v5, v5, v4
    s_mul_i32 s52, s44, 1792
    s_lshl_b32 s64, s53, 4
    s_add_u32 s52, s52, s64
    v_add_u32 v6, s52, v3
    v_lshlrev_b32 v6, 11, v6
    s_lshl_b32 s64, s45, 8
    v_add_u32 v6, s64, v6
    v_lshl_add_u32 v20, v5, 4, v6
    v_add_u32 v21, 16384, v20
    v_add_u32 v22, 128, v20
    v_add_u32 v23, 16384+128, v20
    s_lshr_b32 s65, s3, 1
    s_lshl_b32 s66, s53, 13
    s_lshl_b32 s64, s65, 10
    s_add_u32 s66, s66, s64
    s_lshl_b32 s67, s3, 11
    s_add_u32 s67, s67, 16384
    s_lshl_b32 s52, s46, 1
    s_add_u32 s52, s52, s44
    s_lshl_b32 s52, s52, 7
    s_add_u32 s52, s52, 52461568
    v_and_b32 v5, 31, v2
    v_lshl_add_u32 v24, v5, 2, s52
    v_and_b32 v5, 32, v2
    v_lshl_add_u32 v25, v5, 7, v24
    v_lshl_add_u32 v31, v5, 8, v24
    s_getreg_b32 s75, hwreg(HW_REG_XCC_ID, 0, 4)
    s_add_u32 s75, s75, 1
    s_lshl_b32 s75, s75, 4
    v_mov_b32 v29, s75
    v_cmp_gt_u32 vcc, 32, v2
    s_lshl_b32 s64, s45, 4
    s_add_u32 s52, s52, s64
    v_cndmask_b32 v30, 0, v29, vcc
    s_add_u32 s52, s52, 8192
    v_lshl_add_u32 v33, v2, 2, s52
    s_mov_b32 s75, 0
    s_xor_b32 s52, s52, 128
    s_sub_u32 s52, s52, 4096
    v_and_b32 v5, 3, v2
    v_lshl_add_u32 v34, v5, 2, s52
    buffer_load_dword v27, v24, s[20:23], 0 offen sc1
    s_mul_i32 s52, s45, 7
    v_add_u32 v26, s52, v2
    v_subrev_u32 v5, 7, v2
    v_lshrrev_b32 v6, 2, v5
    v_cmp_le_u32 vcc, s45, v6
    s_nop 1
    v_addc_co_u32 v6, vcc, 0, v6, vcc
    v_and_b32 v7, 3, v5
    v_and_b32 v8, 1, v6
    v_add_u32 v7, v7, v8
    v_mad_u32_u24 v28, v6, 7, v7
    v_cmp_le_u32 vcc, 7, v2
    v_subrev_u32 v5, 35, v2
    v_mul_u32_u24 v6, 43, v5
    v_cndmask_b32 v26, v26, v28, vcc
    v_lshrrev_b32 v6, 7, v6
    v_mul_u32_u24 v7, 3, v6
    v_sub_u32 v7, v5, v7
    v_cmp_le_u32 vcc, s45, v6
    s_nop 1
    v_addc_co_u32 v6, vcc, 0, v6, vcc
    v_and_b32 v8, 1, v6
    v_cmp_eq_u32 vcc, 2, v7
    v_add3_u32 v9, v7, 4, v8
    v_mul_u32_u24 v8, 6, v8
    v_sub_u32 v8, 6, v8
    v_cndmask_b32 v9, v9, v8, vcc
    v_cmp_le_u32 vcc, 35, v2
    v_mad_u32_u24 v28, v6, 7, v9
    s_nop 0
    v_cndmask_b32 v26, v26, v28, vcc
    s_waitcnt lgkmcnt(0)
    s_barrier
    s_mov_b32 s68, s65
    s_mov_b32 s57, 0
    s_mov_b32 s61, 0
KM_l2pro:
    s_waitcnt vmcnt(2)
    v_readlane_b32 s69, v26, s68
    s_add_u32 s68, s68, 2
    s_lshl_b32 s71, s69, 16
    s_add_u32 s60, s67, s57
    s_add_u32 m0, s60, 0
    s_nop 0
    buffer_load_dwordx4 v20, s[28:31], s71 offen lds
    s_add_u32 m0, s60, 1024
    s_nop 0
    buffer_load_dwordx4 v21, s[28:31], s71 offen lds
    s_add_u32 m0, s60, 8192
    s_nop 0
    buffer_load_dwordx4 v22, s[28:31], s71 offen lds
    s_add_u32 m0, s60, 9216
    s_nop 0
    buffer_load_dwordx4 v23, s[28:31], s71 offen lds
    s_add_u32 s57, s57, 32768
    s_cmp_eq_u32 s57, 163840
    s_cselect_b32 s57, 0, s57
    s_add_u32 s61, s61, 1
    s_cmp_lt_u32 s61, 5
    s_cbranch_scc1 KM_l2pro
    s_and_b32 s53, s3, 1
    s_lshl_b32 s64, s53, 2
    s_add_u32 s64, s64, 1
    s_mul_i32 s52, s64, 7
    v_add_u32 v36, s52, v2
    v_subrev_u32 v5, 7, v2
    v_lshrrev_b32 v6, 2, v5
    v_cmp_le_u32 vcc, s64, v6
    s_nop 1
    v_addc_co_u32 v6, vcc, 0, v6, vcc
    v_and_b32 v7, 3, v5
    v_and_b32 v8, 1, v6
    v_add_u32 v7, v7, v8
    v_mad_u32_u24 v28, v6, 7, v7
    v_cmp_le_u32 vcc, 7, v2
    v_subrev_u32 v5, 35, v2
    v_mul_u32_u24 v6, 43, v5
    v_cndmask_b32 v36, v36, v28, vcc
    v_lshrrev_b32 v6, 7, v6
    v_mul_u32_u24 v7, 3, v6
    v_sub_u32 v7, v5, v7
    v_cmp_le_u32 vcc, s64, v6
    s_nop 1
    v_addc_co_u32 v6, vcc, 0, v6, vcc
    v_and_b32 v8, 1, v6
    v_cmp_eq_u32 vcc, 2, v7
    v_add3_u32 v9, v7, 4, v8
    v_mul_u32_u24 v8, 6, v8
    v_sub_u32 v8, 6, v8
    v_cndmask_b32 v9, v9, v8, vcc
    v_cmp_le_u32 vcc, 35, v2
    v_mad_u32_u24 v28, v6, 7, v9
    s_nop 0
    v_cndmask_b32 v36, v36, v28, vcc
    s_mul_i32 s52, s44, 1792
    s_lshr_b32 s64, s2, 3
    s_add_u32 s52, s52, s64
    s_lshl_b32 s52, s52, 11
    s_lshl_b32 s53, s53, 10
    s_add_u32 s52, s52, s53
    s_add_u32 s52, s52, 384
    v_lshl_add_u32 v5, v4, 4, s52
    v_lshl_add_u32 v6, v3, 1, s65
    v_add_u32 v7, 10, v6
    v_min_u32 v7, 55, v7
    v_lshlrev_b32 v7, 2, v7
    ds_bpermute_b32 v37, v7, v36
    v_add_u32 v7, 26, v6
    v_min_u32 v7, 55, v7
    v_lshlrev_b32 v7, 2, v7
    ds_bpermute_b32 v38, v7, v36
    v_add_u32 v7, 42, v6
    v_min_u32 v7, 55, v7
    v_lshlrev_b32 v7, 2, v7
    ds_bpermute_b32 v39, v7, v36
    s_waitcnt lgkmcnt(0)
    v_lshl_add_u32 v37, v37, 16, v5
    v_lshl_add_u32 v38, v38, 16, v5
    v_lshl_add_u32 v39, v39, 16, v5
    buffer_load_dwordx4 v[40:43], v37, s[28:31], 0 offen
    s_lshl_b32 s52, s46, 3
    s_add_u32 s52, s52, s45
    s_lshl_b32 s52, s52, 1
    s_add_u32 s52, s52, s44
    s_lshl_b32 s52, s52, 2
    s_add_u32 s52, s52, s3
    s_lshl_b32 s52, s52, 12
    s_add_u32 s52, s52, 37748736
    v_lshl_add_u32 v5, v2, 4, s52
    v_mov_b32 v48, -1
    v_mov_b32 v49, -1
    v_mov_b32 v50, -1
    v_mov_b32 v51, -1
    buffer_store_dwordx4 v[48:51], v5, s[20:23], 0 offen offset:0 sc1
    buffer_store_dwordx4 v[48:51], v5, s[20:23], 0 offen offset:1024 sc1
    buffer_store_dwordx4 v[48:51], v5, s[20:23], 0 offen offset:2048 sc1
    buffer_store_dwordx4 v[48:51], v5, s[20:23], 0 offen offset:3072 sc1
    s_waitcnt vmcnt(13)
    s_barrier
    buffer_load_dword v27, v24, s[20:23], 0 offen sc1
    s_barrier
    v_readlane_b32 s69, v26, s68
    s_add_u32 s68, s68, 2
    s_lshl_b32 s71, s69, 16
    s_add_u32 s60, s67, s57
    s_add_u32 m0, s60, 0
    s_nop 0
    buffer_load_dwordx4 v20, s[28:31], s71 offen lds
    s_add_u32 m0, s60, 1024
    s_nop 0
    buffer_load_dwordx4 v21, s[28:31], s71 offen lds
    s_add_u32 m0, s60, 8192
    s_nop 0
    buffer_load_dwordx4 v22, s[28:31], s71 offen lds
    s_add_u32 m0, s60, 9216
    s_nop 0
    buffer_load_dwordx4 v23, s[28:31], s71 offen lds
    s_waitcnt vmcnt(4)
    s_mov_b32 s72, 0
KM_c1:
    v_sub_u32 v28, v27, v29
    v_subrev_u32 v28, 1, v28
    v_cmp_le_u32 vcc, 8, v28
    s_and_b32 s53, vcc_lo, vcc_hi
    s_cbranch_scc0 KM_c1_x
    s_add_u32 s72, s72, 1
    s_cmp_gt_u32 s72, 65536
    s_cbranch_scc1 KM_c1_x
    s_cmp_lg_u32 s72, 32
    s_cbranch_scc1 KM_c1_n
    s_mov_b32 s75, 1
    v_mov_b32 v24, v31
    v_mov_b32 v29, v30
    s_cmp_lg_u32 s3, 0
    s_cbranch_scc1 KM_c1_n
    buffer_wbl2 sc1
    v_mov_b32 v28, 1
    s_waitcnt vmcnt(0)
    s_mov_b64 exec, 15
    buffer_store_dword v28, v33, s[20:23], 0 offen sc1
    s_mov_b64 exec, -1
KM_c1_n:
    buffer_load_dword v27, v24, s[20:23], 0 offen sc1
    s_waitcnt vmcnt(0)
    s_branch KM_c1
KM_c1_x:
    s_cmp_eq_u32 s75, 0
    s_cbranch_scc1 KM_c1_y
    v_mov_b32 v24, v25
    buffer_inv sc1
    s_waitcnt vmcnt(0)
KM_c1_y:
    s_add_u32 s68, s65, 6
    s_mov_b32 s57, 98304
    v_readlane_b32 s69, v26, s68
    s_add_u32 s68, s68, 2
    s_cmp_eq_u32 s65, 0
    s_cbranch_scc1 KM_skipA3
    s_lshl_b32 s70, s69, 10
    s_add_u32 s60, s66, s57
    s_add_u32 m0, s60, 0
    s_nop 0
    buffer_load_dwordx4 v16, s[20:23], s70 offen sc1 lds
    s_add_u32 m0, s60, 2048
    s_nop 0
    buffer_load_dwordx4 v17, s[20:23], s70 offen sc1 lds
    s_add_u32 m0, s60, 4096
    s_nop 0
    buffer_load_dwordx4 v18, s[20:23], s70 offen sc1 lds
    s_add_u32 m0, s60, 6144
    s_nop 0
    buffer_load_dwordx4 v19, s[20:23], s70 offen sc1 lds
KM_skipA3:
    s_add_u32 s57, s57, 32768
    s_cmp_eq_u32 s57, 163840
    s_cselect_b32 s57, 0, s57
    v_readlane_b32 s69, v26, s68
    s_add_u32 s68, s68, 2
    s_lshl_b32 s70, s69, 10
    s_add_u32 s60, s66, s57
    s_add_u32 m0, s60, 0
    s_nop 0
    buffer_load_dwordx4 v16, s[20:23], s70 offen sc1 lds
    s_add_u32 m0, s60, 2048
    s_nop 0
    buffer_load_dwordx4 v17, s[20:23], s70 offen sc1 lds
    s_add_u32 m0, s60, 4096
    s_nop 0
    buffer_load_dwordx4 v18, s[20:23], s70 offen sc1 lds
    s_add_u32 m0, s60, 6144
    s_nop 0
    buffer_load_dwordx4 v19, s[20:23], s70 offen sc1 lds
    s_add_u32 s57, s57, 32768
    s_cmp_eq_u32 s57, 163840
    s_cselect_b32 s57, 0, s57
    v_readlane_b32 s69, v26, s68
    s_add_u32 s68, s68, 2
    s_lshl_b32 s70, s69, 10
    s_add_u32 s60, s66, s57
    s_add_u32 m0, s60, 0
    s_nop 0
    buffer_load_dwordx4 v16, s[20:23], s70 offen sc1 lds
    s_add_u32 m0, s60, 2048
    s_nop 0
    buffer_load_dwordx4 v17, s[20:23], s70 offen sc1 lds
    s_add_u32 m0, s60, 4096
    s_nop 0
    buffer_load_dwordx4 v18, s[20:23], s70 offen sc1 lds
    s_add_u32 m0, s60, 6144
    s_nop 0
    buffer_load_dwordx4 v19, s[20:23], s70 offen sc1 lds
    s_add_u32 s57, s57, 32768
    s_cmp_eq_u32 s57, 163840
    s_cselect_b32 s57, 0, s57
    v_readlane_b32 s69, v26, s68
    s_add_u32 s68, s68, 2
    s_add_u32 s60, s67, s57
    s_add_u32 s62, s66, s57
    s_lshl_b32 s71, s69, 16
    s_lshl_b32 s70, s69, 10
    s_mov_b32 m0, s60
    s_add_u32 s57, s57, 32768
    s_cmp_eq_u32 s57, 163840
    s_cselect_b32 s57, 0, s57
    s_waitcnt vmcnt(8)
    s_barrier
    buffer_load_dwordx4 v20, s[28:31], s71 offen lds
    s_add_u32 m0, s60, 1024
    s_nop 0
    buffer_load_dwordx4 v21, s[28:31], s71 offen lds
    s_add_u32 m0, s60, 8192
    s_nop 0
    buffer_load_dwordx4 v22, s[28:31], s71 offen lds
    s_add_u32 m0, s60, 9216
    s_nop 0
    buffer_load_dwordx4 v23, s[28:31], s71 offen lds
    s_add_u32 m0, s62, 0
    s_nop 0
    buffer_load_dwordx4 v16, s[20:23], s70 offen sc1 lds
    s_add_u32 m0, s62, 2048
    s_nop 0
    buffer_load_dwordx4 v17, s[20:23], s70 offen sc1 lds
    s_add_u32 m0, s62, 4096
    s_nop 0
    buffer_load_dwordx4 v18, s[20:23], s70 offen sc1 lds
    s_add_u32 m0, s62, 6144
    s_nop 0
    buffer_load_dwordx4 v19, s[20:23], s70 offen sc1 lds
    v_readlane_b32 s69, v26, s68
    s_add_u32 s68, s68, 2
    s_add_u32 s60, s67, s57
    s_add_u32 s62, s66, s57
    s_lshl_b32 s71, s69, 16
    s_lshl_b32 s70, s69, 10
    s_mov_b32 m0, s60
    s_add_u32 s57, s57, 32768
    s_cmp_eq_u32 s57, 163840
    s_cselect_b32 s57, 0, s57
    s_waitcnt vmcnt(12)
    s_barrier
    buffer_load_dwordx4 v20, s[28:31], s71 offen lds
    s_add_u32 m0, s60, 1024
    s_nop 0
    buffer_load_dwordx4 v21, s[28:31], s71 offen lds
    s_add_u32 m0, s60, 8192
    s_nop 0
    buffer_load_dwordx4 v22, s[28:31], s71 offen lds
    s_add_u32 m0, s60, 9216
    s_nop 0
    buffer_load_dwordx4 v23, s[28:31], s71 offen lds
    s_add_u32 m0, s62, 0
    s_nop 0
    buffer_load_dwordx4 v16, s[20:23], s70 offen sc1 lds
    s_add_u32 m0, s62, 2048
    s_nop 0
    buffer_load_dwordx4 v17, s[20:23], s70 offen sc1 lds
    s_add_u32 m0, s62, 4096
    s_nop 0
    buffer_load_dwordx4 v18, s[20:23], s70 offen sc1 lds
    s_add_u32 m0, s62, 6144
    s_nop 0
    buffer_load_dwordx4 v19, s[20:23], s70 offen sc1 lds
    s_mov_b32 s61, 4
KM_l2loop:
    s_cmp_lg_u32 s61, 10
    s_cbranch_scc1 KM_nolook
    buffer_load_dword v27, v24, s[20:23], 0 offen sc1
KM_nolook:
    s_cmp_lg_u32 s61, 18
    s_cbranch_scc1 KM_nolook2
    buffer_load_dword v35, v34, s[20:23], 0 offen sc1
KM_nolook2:
    s_and_b32 s53, s61, 7
    s_cmp_lg_u32 s53, 5
    s_cbranch_scc1 KM_noc3
    buffer_load_dwordx4 v[40:43], v38, s[28:31], 0 offen
    v_mov_b32 v38, v39
KM_noc3:
    v_readlane_b32 s69, v26, s68
    s_add_u32 s68, s68, 2
    s_add_u32 s60, s67, s57
    s_add_u32 s62, s66, s57
    s_lshl_b32 s71, s69, 16
    s_lshl_b32 s70, s69, 10
    s_mov_b32 m0, s60
    s_add_u32 s57, s57, 32768
    s_cmp_eq_u32 s57, 163840
    s_cselect_b32 s57, 0, s57
    s_cmp_lg_u32 s61, 12
    s_waitcnt vmcnt(16)
    s_cbranch_scc1 KM_c2_y
    s_mov_b32 s72, 0
KM_c2:
    v_sub_u32 v28, v27, v29
    v_subrev_u32 v28, 2, v28
    v_cmp_le_u32 vcc, 8, v28
    s_and_b32 s53, vcc_lo, vcc_hi
    s_cbranch_scc0 KM_c2_x
    s_add_u32 s72, s72, 1
    s_cmp_gt_u32 s72, 65536
    s_cbranch_scc1 KM_c2_x
    buffer_load_dword v27, v24, s[20:23], 0 offen sc1
    s_waitcnt vmcnt(0)
    s_branch KM_c2
KM_c2_x:
    s_cmp_eq_u32 s75, 0
    s_cbranch_scc1 KM_c2_y
    v_mov_b32 v24, v25
    buffer_inv sc1
    s_waitcnt vmcnt(0)
KM_c2_y:
    s_barrier
    buffer_load_dwordx4 v20, s[28:31], s71 offen lds
    s_add_u32 m0, s60, 1024
    s_nop 0
    buffer_load_dwordx4 v21, s[28:31], s71 offen lds
    s_add_u32 m0, s60, 8192
    s_nop 0
    buffer_load_dwordx4 v22, s[28:31], s71 offen lds
    s_add_u32 m0, s60, 9216
    s_nop 0
    buffer_load_dwordx4 v23, s[28:31], s71 offen lds
    s_add_u32 m0, s62, 0
    s_nop 0
    buffer_load_dwordx4 v16, s[20:23], s70 offen sc1 lds
    s_add_u32 m0, s62, 2048
    s_nop 0
    buffer_load_dwordx4 v17, s[20:23], s70 offen sc1 lds
    s_add_u32 m0, s62, 4096
    s_nop 0
    buffer_load_dwordx4 v18, s[20:23], s70 offen sc1 lds
    s_add_u32 m0, s62, 6144
    s_nop 0
    buffer_load_dwordx4 v19, s[20:23], s70 offen sc1 lds
    s_add_u32 s61, s61, 1
    s_cmp_lt_u32 s61, 24
    s_cbranch_scc1 KM_l2loop
    s_mov_b32 s72, 0
KM_ppoll:
    v_cmp_ne_u32 vcc, 2, v35
    s_cbranch_vccz KM_ppoll_x
    buffer_load_dword v35, v34, s[20:23], 0 offen sc1
    s_add_u32 s72, s72, 1
    s_cmp_gt_u32 s72, 65536
    s_waitcnt vmcnt(0)
    s_cbranch_scc0 KM_ppoll
KM_ppoll_x:
    s_waitcnt vmcnt(16)
    s_barrier
    s_waitcnt vmcnt(8)
    s_barrier
    s_waitcnt vmcnt(0)
    s_barrier
    s_endpgm
KM_compute:
    s_lshr_b32 s52, s3, 1
    s_and_b32 s53, s3, 1
    v_lshrrev_b32 v3, 4, v2
    v_and_b32 v4, 15, v2
    s_lshl_b32 s54, s53, 6
    s_add_u32 s54, s54, s50
    v_lshl_add_u32 v5, v3, 3, s54
    v_lshl_add_u32 v6, v3, 3, s51
    s_mov_b32 s28, s6
    s_mov_b32 s29, s7
    s_mov_b32 s30, 7168
    s_mov_b32 s31, 0x20000
    buffer_load_dwordx2 v[160:161], v5, s[28:31], 0 offen offset:0
    buffer_load_dwordx2 v[162:163], v5, s[28:31], 0 offen offset:32
    buffer_load_dwordx2 v[164:165], v5, s[28:31], 0 offen offset:128
    buffer_load_dwordx2 v[166:167], v5, s[28:31], 0 offen offset:160
    buffer_load_dwordx2 v[168:169], v5, s[28:31], 0 offen offset:256
    buffer_load_dwordx2 v[170:171], v5, s[28:31], 0 offen offset:288
    buffer_load_dwordx2 v[172:173], v6, s[28:31], 0 offen offset:0
    buffer_load_dwordx2 v[174:175], v6, s[28:31], 0 offen offset:32
    v_cmp_eq_u32 vcc, 0, v2
    v_mov_b32 v13, 67108864
    s_lshl_b32 s54, s46, 4
    s_add_u32 s54, s54, s47
    s_lshl_b32 s54, s54, 7
    s_add_u32 s54, s54, 52428800
    v_mov_b32 v12, s54
    v_cndmask_b32 v14, v13, v12, vcc
    v_mov_b32 v15, 1
    s_waitcnt vmcnt(8)
    s_barrier
    s_cmp_lg_u32 s3, 0
    s_cbranch_scc1 KM_norp
    buffer_store_dword v15, v14, s[20:23], 0 offen sc1
KM_norp:
    buffer_store_dwordx4 v[40:43], v39, s[20:23], 0 offen offset:0 sc1
    buffer_store_dwordx4 v[44:47], v39, s[20:23], 0 offen offset:1024 sc1
    s_mov_b32 s16, s14
    s_mov_b32 s17, s15
    s_mov_b32 s18, 2048
    s_mov_b32 s19, 0x20000
    s_mov_b32 s36, s8
    s_mov_b32 s37, s9
    s_mov_b32 s38, 4194304
    s_mov_b32 s39, 0x20000
    s_lshl_b32 s54, s46, 1
    s_add_u32 s54, s54, s44
    s_lshl_b32 s54, s54, 3
    s_add_u32 s54, s54, s45
    s_lshl_b32 s54, s54, 2
    s_add_u32 s54, s54, s3
    s_lshl_b32 s54, s54, 2
    s_add_u32 s54, s54, 52461568
    v_mov_b32 v12, s54
    v_cndmask_b32 v14, v13, v12, vcc
    s_lshl_b32 s60, s52, 13
    s_lshl_b32 s61, s53, 12
    s_add_u32 s54, s60, s61
    s_xor_b32 s55, s54, 4096
    v_lshrrev_b32 v8, 1, v4
    v_xor_b32 v8, v8, v3
    v_lshlrev_b32 v8, 4, v8
    v_lshl_add_u32 v7, v4, 7, v8
    v_add_u32 v20, s54, v7
    v_add_u32 v21, s55, v7
    v_xor_b32 v7, 64, v7
    v_add_u32 v22, s54, v7
    v_add_u32 v23, s55, v7
    v_lshrrev_b32 v7, 2, v4
    v_lshl_add_u32 v7, v3, 3, v7
    v_and_b32 v8, 3, v4
    v_lshlrev_b32 v8, 3, v8
    v_lshl_add_u32 v9, v7, 7, v8
    v_add_u32 v9, 16384, v9
    v_and_b32 v10, 1, v3
    v_lshrrev_b32 v11, 3, v4
    v_lshl_add_u32 v11, v10, 1, v11
    s_lshl_b32 s56, s53, 1
    v_xor_b32 v12, s56, v11
    v_lshl_add_u32 v16, v12, 5, v9
    v_xor_b32 v17, 32, v16
    v_lshl_add_u32 v9, v7, 6, v8
    v_lshl_add_u32 v9, v10, 5, v9
    v_add_u32 v18, 40960, v9
    v_xor_b32 v19, 32, v18
    s_lshl_b32 s56, s46, 3
    s_lshl_b32 s57, s52, 2
    s_add_u32 s56, s56, s57
    s_mul_i32 s56, s56, 114688
    s_mul_i32 s57, s47, 7168
    s_add_u32 s56, s56, s57
    s_add_u32 s56, s56, 20971520
    s_add_u32 s57, s53, s48
    s_lshl_b32 s58, s57, 10
    s_add_u32 s58, s58, s56
    v_lshl_add_u32 v240, v2, 4, s58
    s_lshr_b32 s58, s57, 1
    s_lshl_b32 s58, s58, 15
    s_and_b32 s57, s57, 1
    s_lshl_b32 s57, s57, 10
    s_add_u32 s58, s58, s57
    s_add_u32 s57, s58, s54
    v_lshl_add_u32 v242, v2, 4, s57
    s_add_u32 s57, s58, s55
    v_lshl_add_u32 v243, v2, 4, s57
    s_cmp_eq_u32 s48, 0
    s_cselect_b32 s58, 6144, 0
    s_cselect_b32 s59, 98304, 0
    s_add_u32 s58, s58, s56
    v_lshl_add_u32 v241, v2, 4, s58
    s_add_u32 s59, s59, s54
    v_lshl_add_u32 v244, v2, 4, s59
    s_mul_i32 s70, s53, 229376
    s_add_u32 s71, s70, 114688
    s_sub_u32 s72, 229376, s70
    s_add_u32 s73, s72, 114688
    s_lshl_b32 s61, s44, 12
    s_add_u32 s62, s60, s61
    v_lshl_add_u32 v249, v2, 4, s62
    s_xor_b32 s62, s62, 4096
    v_lshl_add_u32 v250, v2, 4, s62
    v_lshrrev_b32 v7, 2, v4
    v_lshl_add_u32 v7, v3, 2, v7
    v_lshl_add_u32 v9, v7, 7, v8
    s_lshl_b32 s54, s53, 13
    s_add_u32 s54, s54, 16384
    v_add_u32 v9, s54, v9
    v_bfe_u32 v11, v7, 1, 2
    v_lshl_add_u32 v245, v11, 5, v9
    v_xor_b32 v246, 32, v245
    v_xor_b32 v247, 64, v245
    v_xor_b32 v248, 0x60, v245
    v_lshrrev_b32 v8, 1, v3
    v_lshlrev_b32 v7, 4, v10
    v_lshl_add_u32 v7, v8, 3, v7
    s_lshl_b32 s54, s45, 7
    s_lshl_b32 s55, s53, 6
    s_add_u32 s54, s54, s55
    v_add_u32 v7, s54, v7
    v_lshlrev_b32 v252, 1, v7
    s_lshr_b32 s54, s45, 2
    s_lshl_b32 s54, s54, 10
    s_add_u32 s54, s54, 4476928
    v_add_u32 v255, s54, v252
    s_lshl_b32 s54, s46, 7
    s_lshl_b32 s55, s52, 6
    s_add_u32 s54, s54, s55
    s_lshl_b32 s55, s44, 5
    s_add_u32 s54, s54, s55
    v_add_u32 v9, s54, v4
    v_lshl_add_u32 v251, v9, 11, v252
    s_lshl_b32 s54, s46, 3
    s_add_u32 s54, s54, s45
    s_lshl_b32 s54, s54, 1
    s_add_u32 s54, s54, s44
    s_lshl_b32 s54, s54, 2
    s_add_u32 s68, s54, s3
    s_xor_b32 s69, s68, 4
    s_lshl_b32 s54, s68, 12
    s_add_u32 s54, s54, 37748736
    v_lshl_add_u32 v254, v2, 4, s54
    s_lshl_b32 s54, s69, 12
    s_add_u32 s54, s54, 37748736
    v_lshl_add_u32 v253, v2, 4, s54
    v_mov_b32 v4, 0xbdd2d3e8
    v_mov_b32 v5, 0xc0135761
    s_getreg_b32 s64, hwreg(HW_REG_XCC_ID, 0, 4)
    s_add_u32 s64, s64, 1
    s_lshl_b32 s64, s64, 4
    s_add_u32 s64, s64, 1
    s_add_u32 s65, s64, 1
    s_mov_b32 s74, 32768
    s_mov_b32 s75, 4096
    s_mov_b32 s66, 12582912
    s_mov_b32 s67, 12615680
    buffer_load_dwordx4 v[24:27], v252, s[16:19], 0 offen
    buffer_load_dwordx4 v[28:31], v252, s[16:19], 0 offen offset:64
    s_waitcnt vmcnt(5)
    s_cmp_eq_u32 s3, 0
    s_cbranch_scc1 KM_bw
    s_waitcnt vmcnt(4)
KM_bw:
    v_lshlrev_b32 v32, 16, v160
    v_and_b32 v33, 0xffff0000, v160
    v_lshlrev_b32 v34, 16, v161
    v_and_b32 v35, 0xffff0000, v161
    v_mov_b64 v[36:37], v[32:33]
    v_mov_b64 v[38:39], v[34:35]
    v_mov_b64 v[40:41], v[32:33]
    v_mov_b64 v[42:43], v[34:35]
    v_mov_b64 v[44:45], v[32:33]
    v_mov_b64 v[46:47], v[34:35]
    v_lshlrev_b32 v48, 16, v162
    v_and_b32 v49, 0xffff0000, v162
    v_lshlrev_b32 v50, 16, v163
    v_and_b32 v51, 0xffff0000, v163
    v_mov_b64 v[52:53], v[48:49]
    v_mov_b64 v[54:55], v[50:51]
    v_mov_b64 v[56:57], v[48:49]
    v_mov_b64 v[58:59], v[50:51]
    v_mov_b64 v[60:61], v[48:49]
    v_mov_b64 v[62:63], v[50:51]
    v_lshlrev_b32 v64, 16, v164
    v_and_b32 v65, 0xffff0000, v164
    v_lshlrev_b32 v66, 16, v165
    v_and_b32 v67, 0xffff0000, v165
    v_mov_b64 v[68:69], v[64:65]
    v_mov_b64 v[70:71], v[66:67]
    v_mov_b64 v[72:73], v[64:65]
    v_mov_b64 v[74:75], v[66:67]
    v_mov_b64 v[76:77], v[64:65]
    v_mov_b64 v[78:79], v[66:67]
    v_lshlrev_b32 v80, 16, v166
    v_and_b32 v81, 0xffff0000, v166
    v_lshlrev_b32 v82, 16, v167
    v_and_b32 v83, 0xffff0000, v167
    v_mov_b64 v[84:85], v[80:81]
    v_mov_b64 v[86:87], v[82:83]
    v_mov_b64 v[88:89], v[80:81]
    v_mov_b64 v[90:91], v[82:83]
    v_mov_b64 v[92:93], v[80:81]
    v_mov_b64 v[94:95], v[82:83]
    v_lshlrev_b32 v96, 16, v168
    v_and_b32 v97, 0xffff0000, v168
    v_lshlrev_b32 v98, 16, v169
    v_and_b32 v99, 0xffff0000, v169
    v_mov_b64 v[100:101], v[96:97]
    v_mov_b64 v[102:103], v[98:99]
    v_mov_b64 v[104:105], v[96:97]
    v_mov_b64 v[106:107], v[98:99]
    v_mov_b64 v[108:109], v[96:97]
    v_mov_b64 v[110:111], v[98:99]
    v_lshlrev_b32 v112, 16, v170
    v_and_b32 v113, 0xffff0000, v170
    v_lshlrev_b32 v114, 16, v171
    v_and_b32 v115, 0xffff0000, v171
    v_mov_b64 v[116:117], v[112:113]
    v_mov_b64 v[118:119], v[114:115]
    v_mov_b64 v[120:121], v[112:113]
    v_mov_b64 v[122:123], v[114:115]
    v_mov_b64 v[124:125], v[112:113]
    v_mov_b64 v[126:127], v[114:115]
    v_lshlrev_b32 v128, 16, v172
    v_and_b32 v129, 0xffff0000, v172
    v_lshlrev_b32 v130, 16, v173
    v_and_b32 v131, 0xffff0000, v173
    v_mov_b64 v[132:133], v[128:129]
    v_mov_b64 v[134:135], v[130:131]
    v_lshlrev_b32 v136, 16, v174
    v_and_b32 v137, 0xffff0000, v174
    v_lshlrev_b32 v138, 16, v175
    v_and_b32 v139, 0xffff0000, v175
    v_mov_b64 v[140:141], v[136:137]
    v_mov_b64 v[142:143], v[138:139]
    s_mov_b32 s57, 1
    s_mov_b32 s59, 45056
    s_mov_b32 s58, 45056
    s_mov_b32 s61, 0
    s_barrier
    ds_read_b64_tr_b16 v[144:145], v16 offset:0
    ds_read_b64_tr_b16 v[146:147], v16 offset:512
    ds_read_b128 v[176:179], v20 offset:0
    ds_read_b128 v[180:183], v20 offset:2048
    ds_read_b128 v[184:187], v21 offset:0
    ds_read_b128 v[188:191], v21 offset:2048
    ds_read_b64_tr_b16 v[148:149], v17 offset:0
    ds_read_b64_tr_b16 v[150:151], v17 offset:512
    ds_read_b64_tr_b16 v[152:153], v16 offset:8192
    ds_read_b64_tr_b16 v[154:155], v16 offset:8704
    ds_read_b64_tr_b16 v[156:157], v17 offset:8192
    ds_read_b64_tr_b16 v[158:159], v17 offset:8704
    ds_read_b64_tr_b16 v[160:161], v16 offset:16384
    ds_read_b64_tr_b16 v[162:163], v16 offset:16896
    ds_read_b64_tr_b16 v[164:165], v17 offset:16384
    ds_read_b64_tr_b16 v[166:167], v17 offset:16896
    ds_read_b64_tr_b16 v[168:169], v18 offset:0
    ds_read_b64_tr_b16 v[170:171], v18 offset:256
    ds_read_b64_tr_b16 v[172:173], v19 offset:0
    ds_read_b64_tr_b16 v[174:175], v19 offset:256
    s_waitcnt lgkmcnt(0)
KM_cloop:
    v_mfma_f32_16x16x32_bf16 v[32:35], v[144:147], v[176:179], v[32:35]
    ds_read_b64_tr_b16 v[192:193], v16 offset:4096
    v_mfma_f32_16x16x32_bf16 v[36:39], v[144:147], v[180:183], v[36:39]
    ds_read_b64_tr_b16 v[194:195], v16 offset:4608
    v_mfma_f32_16x16x32_bf16 v[40:43], v[144:147], v[184:187], v[40:43]
    ds_read_b128 v[224:227], v22 offset:0
    v_mfma_f32_16x16x32_bf16 v[44:47], v[144:147], v[188:191], v[44:47]
    ds_read_b128 v[228:231], v22 offset:2048
    v_mfma_f32_16x16x32_bf16 v[48:51], v[148:151], v[176:179], v[48:51]
    ds_read_b128 v[232:235], v23 offset:0
    v_mfma_f32_16x16x32_bf16 v[52:55], v[148:151], v[180:183], v[52:55]
    ds_read_b128 v[236:239], v23 offset:2048
    v_mfma_f32_16x16x32_bf16 v[56:59], v[148:151], v[184:187], v[56:59]
    ds_read_b64_tr_b16 v[196:197], v17 offset:4096
    v_mfma_f32_16x16x32_bf16 v[60:63], v[148:151], v[188:191], v[60:63]
    ds_read_b64_tr_b16 v[198:199], v17 offset:4608
    v_mfma_f32_16x16x32_bf16 v[64:67], v[152:155], v[176:179], v[64:67]
    ds_read_b64_tr_b16 v[200:201], v16 offset:12288
    v_mfma_f32_16x16x32_bf16 v[68:71], v[152:155], v[180:183], v[68:71]
    ds_read_b64_tr_b16 v[202:203], v16 offset:12800
    v_mfma_f32_16x16x32_bf16 v[72:75], v[152:155], v[184:187], v[72:75]
    ds_read_b64_tr_b16 v[204:205], v17 offset:12288
    v_mfma_f32_16x16x32_bf16 v[76:79], v[152:155], v[188:191], v[76:79]
    ds_read_b64_tr_b16 v[206:207], v17 offset:12800
    v_mfma_f32_16x16x32_bf16 v[80:83], v[156:159], v[176:179], v[80:83]
    ds_read_b64_tr_b16 v[208:209], v16 offset:20480
    v_mfma_f32_16x16x32_bf16 v[84:87], v[156:159], v[180:183], v[84:87]
    ds_read_b64_tr_b16 v[210:211], v16 offset:20992
    v_mfma_f32_16x16x32_bf16 v[88:91], v[156:159], v[184:187], v[88:91]
    ds_read_b64_tr_b16 v[212:213], v17 offset:20480
    v_mfma_f32_16x16x32_bf16 v[92:95], v[156:159], v[188:191], v[92:95]
    ds_read_b64_tr_b16 v[214:215], v17 offset:20992
    v_mfma_f32_16x16x32_bf16 v[96:99], v[160:163], v[176:179], v[96:99]
    ds_read_b64_tr_b16 v[216:217], v18 offset:2048
    v_mfma_f32_16x16x32_bf16 v[100:103], v[160:163], v[180:183], v[100:103]
    ds_read_b64_tr_b16 v[218:219], v18 offset:2304
    v_mfma_f32_16x16x32_bf16 v[104:107], v[160:163], v[184:187], v[104:107]
    ds_read_b64_tr_b16 v[220:221], v19 offset:2048
    v_mfma_f32_16x16x32_bf16 v[108:111], v[160:163], v[188:191], v[108:111]
    ds_read_b64_tr_b16 v[222:223], v19 offset:2304
    v_mfma_f32_16x16x32_bf16 v[112:115], v[164:167], v[176:179], v[112:115]
    v_add_u32 v16, s58, v16
    v_add_u32 v17, s58, v17
    v_mfma_f32_16x16x32_bf16 v[116:119], v[164:167], v[180:183], v[116:119]
    v_add_u32 v18, s58, v18
    v_add_u32 v19, s58, v19
    v_mfma_f32_16x16x32_bf16 v[120:123], v[164:167], v[184:187], v[120:123]
    v_add_u32 v20, s58, v20
    v_add_u32 v21, s58, v21
    v_mfma_f32_16x16x32_bf16 v[124:127], v[164:167], v[188:191], v[124:127]
    v_add_u32 v22, s58, v22
    v_add_u32 v23, s58, v23
    v_mfma_f32_16x16x32_bf16 v[128:131], v[168:171], v[176:179], v[128:131]
    v_mfma_f32_16x16x32_bf16 v[132:135], v[168:171], v[180:183], v[132:135]
    v_mfma_f32_16x16x32_bf16 v[136:139], v[172:175], v[176:179], v[136:139]
    s_waitcnt lgkmcnt(0)
    s_barrier
    v_mfma_f32_16x16x32_bf16 v[140:143], v[172:175], v[180:183], v[140:143]
    v_mfma_f32_16x16x32_bf16 v[32:35], v[192:195], v[224:227], v[32:35]
    ds_read_b64_tr_b16 v[144:145], v16 offset:0
    v_mfma_f32_16x16x32_bf16 v[36:39], v[192:195], v[228:231], v[36:39]
    ds_read_b64_tr_b16 v[146:147], v16 offset:512
    v_mfma_f32_16x16x32_bf16 v[40:43], v[192:195], v[232:235], v[40:43]
    ds_read_b128 v[176:179], v20 offset:0
    v_mfma_f32_16x16x32_bf16 v[44:47], v[192:195], v[236:239], v[44:47]
    ds_read_b128 v[180:183], v20 offset:2048
    v_mfma_f32_16x16x32_bf16 v[48:51], v[196:199], v[224:227], v[48:51]
    ds_read_b128 v[184:187], v21 offset:0
    v_mfma_f32_16x16x32_bf16 v[52:55], v[196:199], v[228:231], v[52:55]
    ds_read_b128 v[188:191], v21 offset:2048
    v_mfma_f32_16x16x32_bf16 v[56:59], v[196:199], v[232:235], v[56:59]
    ds_read_b64_tr_b16 v[148:149], v17 offset:0
    v_mfma_f32_16x16x32_bf16 v[60:63], v[196:199], v[236:239], v[60:63]
    ds_read_b64_tr_b16 v[150:151], v17 offset:512
    v_mfma_f32_16x16x32_bf16 v[64:67], v[200:203], v[224:227], v[64:67]
    ds_read_b64_tr_b16 v[152:153], v16 offset:8192
    v_mfma_f32_16x16x32_bf16 v[68:71], v[200:203], v[228:231], v[68:71]
    ds_read_b64_tr_b16 v[154:155], v16 offset:8704
    v_mfma_f32_16x16x32_bf16 v[72:75], v[200:203], v[232:235], v[72:75]
    ds_read_b64_tr_b16 v[156:157], v17 offset:8192
    v_mfma_f32_16x16x32_bf16 v[76:79], v[200:203], v[236:239], v[76:79]
    ds_read_b64_tr_b16 v[158:159], v17 offset:8704
    v_mfma_f32_16x16x32_bf16 v[80:83], v[204:207], v[224:227], v[80:83]
    ds_read_b64_tr_b16 v[160:161], v16 offset:16384
    v_mfma_f32_16x16x32_bf16 v[84:87], v[204:207], v[228:231], v[84:87]
    ds_read_b64_tr_b16 v[162:163], v16 offset:16896
    v_mfma_f32_16x16x32_bf16 v[88:91], v[204:207], v[232:235], v[88:91]
    ds_read_b64_tr_b16 v[164:165], v17 offset:16384
    v_mfma_f32_16x16x32_bf16 v[92:95], v[204:207], v[236:239], v[92:95]
    ds_read_b64_tr_b16 v[166:167], v17 offset:16896
    v_mfma_f32_16x16x32_bf16 v[96:99], v[208:211], v[224:227], v[96:99]
    ds_read_b64_tr_b16 v[168:169], v18 offset:0
    v_mfma_f32_16x16x32_bf16 v[100:103], v[208:211], v[228:231], v[100:103]
    ds_read_b64_tr_b16 v[170:171], v18 offset:256
    v_mfma_f32_16x16x32_bf16 v[104:107], v[208:211], v[232:235], v[104:107]
    ds_read_b64_tr_b16 v[172:173], v19 offset:0
    v_mfma_f32_16x16x32_bf16 v[108:111], v[208:211], v[236:239], v[108:111]
    ds_read_b64_tr_b16 v[174:175], v19 offset:256
    v_mfma_f32_16x16x32_bf16 v[112:115], v[212:215], v[224:227], v[112:115]
    s_add_u32 s57, s57, 1
    v_mfma_f32_16x16x32_bf16 v[116:119], v[212:215], v[228:231], v[116:119]
    s_cmp_eq_u32 s57, 3
    v_mfma_f32_16x16x32_bf16 v[120:123], v[212:215], v[232:235], v[120:123]
    s_cselect_b32 s58, 4294877184, s59
    v_mfma_f32_16x16x32_bf16 v[124:127], v[212:215], v[236:239], v[124:127]
    s_cselect_b32 s57, 0, s57
    v_mfma_f32_16x16x32_bf16 v[128:131], v[216:219], v[224:227], v[128:131]
    s_add_u32 s61, s61, 1
    v_mfma_f32_16x16x32_bf16 v[132:135], v[216:219], v[228:231], v[132:135]
    s_cmp_lt_u32 s61, 16
    v_mfma_f32_16x16x32_bf16 v[136:139], v[220:223], v[224:227], v[136:139]
    s_waitcnt lgkmcnt(0)
    v_mfma_f32_16x16x32_bf16 v[140:143], v[220:223], v[228:231], v[140:143]
    s_cbranch_scc1 KM_cloop
KM_gelu:
    v_pk_mul_f32 v[160:161], v[32:33], v[32:33]
    v_pk_mul_f32 v[162:163], v[34:35], v[34:35]
    v_pk_mul_f32 v[164:165], v[48:49], v[48:49]
    v_pk_mul_f32 v[166:167], v[50:51], v[50:51]
    v_pk_fma_f32 v[160:161], v[160:161], v[4:5], v[4:5] op_sel:[0,0,1] op_sel_hi:[1,0,1]
    v_pk_fma_f32 v[162:163], v[162:163], v[4:5], v[4:5] op_sel:[0,0,1] op_sel_hi:[1,0,1]
    v_pk_fma_f32 v[164:165], v[164:165], v[4:5], v[4:5] op_sel:[0,0,1] op_sel_hi:[1,0,1]
    v_pk_fma_f32 v[166:167], v[166:167], v[4:5], v[4:5] op_sel:[0,0,1] op_sel_hi:[1,0,1]
    v_pk_mul_f32 v[160:161], v[160:161], v[32:33]
    v_pk_mul_f32 v[162:163], v[162:163], v[34:35]
    v_pk_mul_f32 v[164:165], v[164:165], v[48:49]
    v_pk_mul_f32 v[166:167], v[166:167], v[50:51]
    v_exp_f32 v160, v160
    v_exp_f32 v161, v161
    v_exp_f32 v162, v162
    v_exp_f32 v163, v163
    v_exp_f32 v164, v164
    v_exp_f32 v165, v165
    v_exp_f32 v166, v166
    v_exp_f32 v167, v167
    v_pk_add_f32 v[160:161], v[160:161], 1.0 op_sel_hi:[1,0]
    v_pk_add_f32 v[162:163], v[162:163], 1.0 op_sel_hi:[1,0]
    v_pk_add_f32 v[164:165], v[164:165], 1.0 op_sel_hi:[1,0]
    v_pk_add_f32 v[166:167], v[166:167], 1.0 op_sel_hi:[1,0]
    v_rcp_f32 v160, v160
    v_rcp_f32 v161, v161
    v_rcp_f32 v162, v162
    v_rcp_f32 v163, v163
    v_rcp_f32 v164, v164
    v_rcp_f32 v165, v165
    v_rcp_f32 v166, v166
    v_rcp_f32 v167, v167
    v_pk_mul_f32 v[160:161], v[160:161], v[32:33]
    v_pk_mul_f32 v[162:163], v[162:163], v[34:35]
    v_pk_mul_f32 v[164:165], v[164:165], v[48:49]
    v_pk_mul_f32 v[166:167], v[166:167], v[50:51]
    v_cvt_pk_bf16_f32 v168, v160, v161
    v_cvt_pk_bf16_f32 v169, v162, v163
    v_cvt_pk_bf16_f32 v170, v164, v165
    v_cvt_pk_bf16_f32 v171, v166, v167
    v_pk_mul_f32 v[160:161], v[36:37], v[36:37]
    v_pk_mul_f32 v[162:163], v[38:39], v[38:39]
    v_pk_mul_f32 v[164:165], v[52:53], v[52:53]
    v_pk_mul_f32 v[166:167], v[54:55], v[54:55]
    v_pk_fma_f32 v[160:161], v[160:161], v[4:5], v[4:5] op_sel:[0,0,1] op_sel_hi:[1,0,1]
    v_pk_fma_f32 v[162:163], v[162:163], v[4:5], v[4:5] op_sel:[0,0,1] op_sel_hi:[1,0,1]
    v_pk_fma_f32 v[164:165], v[164:165], v[4:5], v[4:5] op_sel:[0,0,1] op_sel_hi:[1,0,1]
    v_pk_fma_f32 v[166:167], v[166:167], v[4:5], v[4:5] op_sel:[0,0,1] op_sel_hi:[1,0,1]
    v_pk_mul_f32 v[160:161], v[160:161], v[36:37]
    v_pk_mul_f32 v[162:163], v[162:163], v[38:39]
    v_pk_mul_f32 v[164:165], v[164:165], v[52:53]
    v_pk_mul_f32 v[166:167], v[166:167], v[54:55]
    v_exp_f32 v160, v160
    v_exp_f32 v161, v161
    buffer_store_dwordx4 v[168:171], v240, s[20:23], s70 offen offset:0
    v_exp_f32 v162, v162
    v_exp_f32 v163, v163
    v_exp_f32 v164, v164
    v_exp_f32 v165, v165
    v_exp_f32 v166, v166
    v_exp_f32 v167, v167
    v_pk_add_f32 v[160:161], v[160:161], 1.0 op_sel_hi:[1,0]
    v_pk_add_f32 v[162:163], v[162:163], 1.0 op_sel_hi:[1,0]
    v_pk_add_f32 v[164:165], v[164:165], 1.0 op_sel_hi:[1,0]
    v_pk_add_f32 v[166:167], v[166:167], 1.0 op_sel_hi:[1,0]
    v_rcp_f32 v160, v160
    v_rcp_f32 v161, v161
    ds_write_b128 v242, v[168:171] offset:0
    v_rcp_f32 v162, v162
    v_rcp_f32 v163, v163
    v_rcp_f32 v164, v164
    v_rcp_f32 v165, v165
    v_rcp_f32 v166, v166
    v_rcp_f32 v167, v167
    v_pk_mul_f32 v[160:161], v[160:161], v[36:37]
    v_pk_mul_f32 v[162:163], v[162:163], v[38:39]
    v_pk_mul_f32 v[164:165], v[164:165], v[52:53]
    v_pk_mul_f32 v[166:167], v[166:167], v[54:55]
    v_cvt_pk_bf16_f32 v172, v160, v161
    v_cvt_pk_bf16_f32 v173, v162, v163
    v_cvt_pk_bf16_f32 v174, v164, v165
    v_cvt_pk_bf16_f32 v175, v166, v167
    v_pk_mul_f32 v[160:161], v[40:41], v[40:41]
    v_pk_mul_f32 v[162:163], v[42:43], v[42:43]
    v_pk_mul_f32 v[164:165], v[56:57], v[56:57]
    v_pk_mul_f32 v[166:167], v[58:59], v[58:59]
    v_pk_fma_f32 v[160:161], v[160:161], v[4:5], v[4:5] op_sel:[0,0,1] op_sel_hi:[1,0,1]
    v_pk_fma_f32 v[162:163], v[162:163], v[4:5], v[4:5] op_sel:[0,0,1] op_sel_hi:[1,0,1]
    v_pk_fma_f32 v[164:165], v[164:165], v[4:5], v[4:5] op_sel:[0,0,1] op_sel_hi:[1,0,1]
    v_pk_fma_f32 v[166:167], v[166:167], v[4:5], v[4:5] op_sel:[0,0,1] op_sel_hi:[1,0,1]
    v_pk_mul_f32 v[160:161], v[160:161], v[40:41]
    v_pk_mul_f32 v[162:163], v[162:163], v[42:43]
    v_pk_mul_f32 v[164:165], v[164:165], v[56:57]
    v_pk_mul_f32 v[166:167], v[166:167], v[58:59]
    v_exp_f32 v160, v160
    v_exp_f32 v161, v161
    buffer_store_dwordx4 v[172:175], v240, s[20:23], s71 offen offset:0
    v_exp_f32 v162, v162
    v_exp_f32 v163, v163
    v_exp_f32 v164, v164
    v_exp_f32 v165, v165
    v_exp_f32 v166, v166
    v_exp_f32 v167, v167
    v_pk_add_f32 v[160:161], v[160:161], 1.0 op_sel_hi:[1,0]
    v_pk_add_f32 v[162:163], v[162:163], 1.0 op_sel_hi:[1,0]
    v_pk_add_f32 v[164:165], v[164:165], 1.0 op_sel_hi:[1,0]
    v_pk_add_f32 v[166:167], v[166:167], 1.0 op_sel_hi:[1,0]
    v_rcp_f32 v160, v160
    v_rcp_f32 v161, v161
    ds_write_b128 v242, v[172:175] offset:2048
    v_rcp_f32 v162, v162
    v_rcp_f32 v163, v163
    v_rcp_f32 v164, v164
    v_rcp_f32 v165, v165
    v_rcp_f32 v166, v166
    v_rcp_f32 v167, v167
    v_pk_mul_f32 v[160:161], v[160:161], v[40:41]
    v_pk_mul_f32 v[162:163], v[162:163], v[42:43]
    v_pk_mul_f32 v[164:165], v[164:165], v[56:57]
    v_pk_mul_f32 v[166:167], v[166:167], v[58:59]
    v_cvt_pk_bf16_f32 v176, v160, v161
    v_cvt_pk_bf16_f32 v177, v162, v163
    v_cvt_pk_bf16_f32 v178, v164, v165
    v_cvt_pk_bf16_f32 v179, v166, v167
    v_pk_mul_f32 v[160:161], v[44:45], v[44:45]
    v_pk_mul_f32 v[162:163], v[46:47], v[46:47]
    v_pk_mul_f32 v[164:165], v[60:61], v[60:61]
    v_pk_mul_f32 v[166:167], v[62:63], v[62:63]
    v_pk_fma_f32 v[160:161], v[160:161], v[4:5], v[4:5] op_sel:[0,0,1] op_sel_hi:[1,0,1]
    v_pk_fma_f32 v[162:163], v[162:163], v[4:5], v[4:5] op_sel:[0,0,1] op_sel_hi:[1,0,1]
    v_pk_fma_f32 v[164:165], v[164:165], v[4:5], v[4:5] op_sel:[0,0,1] op_sel_hi:[1,0,1]
    v_pk_fma_f32 v[166:167], v[166:167], v[4:5], v[4:5] op_sel:[0,0,1] op_sel_hi:[1,0,1]
    v_pk_mul_f32 v[160:161], v[160:161], v[44:45]
    v_pk_mul_f32 v[162:163], v[162:163], v[46:47]
    v_pk_mul_f32 v[164:165], v[164:165], v[60:61]
    v_pk_mul_f32 v[166:167], v[166:167], v[62:63]
    v_exp_f32 v160, v160
    v_exp_f32 v161, v161
    buffer_store_dwordx4 v[176:179], v240, s[20:23], s72 offen offset:0
    v_exp_f32 v162, v162
    v_exp_f32 v163, v163
    v_exp_f32 v164, v164
    v_exp_f32 v165, v165
    v_exp_f32 v166, v166
    v_exp_f32 v167, v167
    v_pk_add_f32 v[160:161], v[160:161], 1.0 op_sel_hi:[1,0]
    v_pk_add_f32 v[162:163], v[162:163], 1.0 op_sel_hi:[1,0]
    v_pk_add_f32 v[164:165], v[164:165], 1.0 op_sel_hi:[1,0]
    v_pk_add_f32 v[166:167], v[166:167], 1.0 op_sel_hi:[1,0]
    v_rcp_f32 v160, v160
    v_rcp_f32 v161, v161
    ds_write_b128 v243, v[176:179] offset:0
    v_rcp_f32 v162, v162
    v_rcp_f32 v163, v163
    v_rcp_f32 v164, v164
    v_rcp_f32 v165, v165
    v_rcp_f32 v166, v166
    v_rcp_f32 v167, v167
    v_pk_mul_f32 v[160:161], v[160:161], v[44:45]
    v_pk_mul_f32 v[162:163], v[162:163], v[46:47]
    v_pk_mul_f32 v[164:165], v[164:165], v[60:61]
    v_pk_mul_f32 v[166:167], v[166:167], v[62:63]
    v_cvt_pk_bf16_f32 v180, v160, v161
    v_cvt_pk_bf16_f32 v181, v162, v163
    v_cvt_pk_bf16_f32 v182, v164, v165
    v_cvt_pk_bf16_f32 v183, v166, v167
    v_pk_mul_f32 v[160:161], v[64:65], v[64:65]
    v_pk_mul_f32 v[162:163], v[66:67], v[66:67]
    v_pk_mul_f32 v[164:165], v[80:81], v[80:81]
    v_pk_mul_f32 v[166:167], v[82:83], v[82:83]
    v_pk_fma_f32 v[160:161], v[160:161], v[4:5], v[4:5] op_sel:[0,0,1] op_sel_hi:[1,0,1]
    v_pk_fma_f32 v[162:163], v[162:163], v[4:5], v[4:5] op_sel:[0,0,1] op_sel_hi:[1,0,1]
    v_pk_fma_f32 v[164:165], v[164:165], v[4:5], v[4:5] op_sel:[0,0,1] op_sel_hi:[1,0,1]
    v_pk_fma_f32 v[166:167], v[166:167], v[4:5], v[4:5] op_sel:[0,0,1] op_sel_hi:[1,0,1]
    v_pk_mul_f32 v[160:161], v[160:161], v[64:65]
    v_pk_mul_f32 v[162:163], v[162:163], v[66:67]
    v_pk_mul_f32 v[164:165], v[164:165], v[80:81]
    v_pk_mul_f32 v[166:167], v[166:167], v[82:83]
    v_exp_f32 v160, v160
    v_exp_f32 v161, v161
    buffer_store_dwordx4 v[180:183], v240, s[20:23], s73 offen offset:0
    v_exp_f32 v162, v162
    v_exp_f32 v163, v163
    v_exp_f32 v164, v164
    v_exp_f32 v165, v165
    v_exp_f32 v166, v166
    v_exp_f32 v167, v167
    v_pk_add_f32 v[160:161], v[160:161], 1.0 op_sel_hi:[1,0]
    v_pk_add_f32 v[162:163], v[162:163], 1.0 op_sel_hi:[1,0]
    v_pk_add_f32 v[164:165], v[164:165], 1.0 op_sel_hi:[1,0]
    v_pk_add_f32 v[166:167], v[166:167], 1.0 op_sel_hi:[1,0]
    v_rcp_f32 v160, v160
    v_rcp_f32 v161, v161
    ds_write_b128 v243, v[180:183] offset:2048
    v_rcp_f32 v162, v162
    v_rcp_f32 v163, v163
    v_rcp_f32 v164, v164
    v_rcp_f32 v165, v165
    v_rcp_f32 v166, v166
    v_rcp_f32 v167, v167
    v_pk_mul_f32 v[160:161], v[160:161], v[64:65]
    v_pk_mul_f32 v[162:163], v[162:163], v[66:67]
    v_pk_mul_f32 v[164:165], v[164:165], v[80:81]
    v_pk_mul_f32 v[166:167], v[166:167], v[82:83]
    v_cvt_pk_bf16_f32 v184, v160, v161
    v_cvt_pk_bf16_f32 v185, v162, v163
    v_cvt_pk_bf16_f32 v186, v164, v165
    v_cvt_pk_bf16_f32 v187, v166, v167
    v_pk_mul_f32 v[160:161], v[68:69], v[68:69]
    v_pk_mul_f32 v[162:163], v[70:71], v[70:71]
    v_pk_mul_f32 v[164:165], v[84:85], v[84:85]
    v_pk_mul_f32 v[166:167], v[86:87], v[86:87]
    v_pk_fma_f32 v[160:161], v[160:161], v[4:5], v[4:5] op_sel:[0,0,1] op_sel_hi:[1,0,1]
    v_pk_fma_f32 v[162:163], v[162:163], v[4:5], v[4:5] op_sel:[0,0,1] op_sel_hi:[1,0,1]
    v_pk_fma_f32 v[164:165], v[164:165], v[4:5], v[4:5] op_sel:[0,0,1] op_sel_hi:[1,0,1]
    v_pk_fma_f32 v[166:167], v[166:167], v[4:5], v[4:5] op_sel:[0,0,1] op_sel_hi:[1,0,1]
    v_pk_mul_f32 v[160:161], v[160:161], v[68:69]
    v_pk_mul_f32 v[162:163], v[162:163], v[70:71]
    v_pk_mul_f32 v[164:165], v[164:165], v[84:85]
    v_pk_mul_f32 v[166:167], v[166:167], v[86:87]
    v_exp_f32 v160, v160
    v_exp_f32 v161, v161
    buffer_store_dwordx4 v[184:187], v240, s[20:23], s70 offen offset:2048
    v_exp_f32 v162, v162
    v_exp_f32 v163, v163
    v_exp_f32 v164, v164
    v_exp_f32 v165, v165
    v_exp_f32 v166, v166
    v_exp_f32 v167, v167
    v_pk_add_f32 v[160:161], v[160:161], 1.0 op_sel_hi:[1,0]
    v_pk_add_f32 v[162:163], v[162:163], 1.0 op_sel_hi:[1,0]
    v_pk_add_f32 v[164:165], v[164:165], 1.0 op_sel_hi:[1,0]
    v_pk_add_f32 v[166:167], v[166:167], 1.0 op_sel_hi:[1,0]
    v_rcp_f32 v160, v160
    v_rcp_f32 v161, v161
    ds_write_b128 v242, v[184:187] offset:32768
    v_rcp_f32 v162, v162
    v_rcp_f32 v163, v163
    v_rcp_f32 v164, v164
    v_rcp_f32 v165, v165
    v_rcp_f32 v166, v166
    v_rcp_f32 v167, v167
    v_pk_mul_f32 v[160:161], v[160:161], v[68:69]
    v_pk_mul_f32 v[162:163], v[162:163], v[70:71]
    v_pk_mul_f32 v[164:165], v[164:165], v[84:85]
    v_pk_mul_f32 v[166:167], v[166:167], v[86:87]
    v_cvt_pk_bf16_f32 v188, v160, v161
    v_cvt_pk_bf16_f32 v189, v162, v163
    v_cvt_pk_bf16_f32 v190, v164, v165
    v_cvt_pk_bf16_f32 v191, v166, v167
    v_pk_mul_f32 v[160:161], v[72:73], v[72:73]
    v_pk_mul_f32 v[162:163], v[74:75], v[74:75]
    v_pk_mul_f32 v[164:165], v[88:89], v[88:89]
    v_pk_mul_f32 v[166:167], v[90:91], v[90:91]
    v_pk_fma_f32 v[160:161], v[160:161], v[4:5], v[4:5] op_sel:[0,0,1] op_sel_hi:[1,0,1]
    v_pk_fma_f32 v[162:163], v[162:163], v[4:5], v[4:5] op_sel:[0,0,1] op_sel_hi:[1,0,1]
    v_pk_fma_f32 v[164:165], v[164:165], v[4:5], v[4:5] op_sel:[0,0,1] op_sel_hi:[1,0,1]
    v_pk_fma_f32 v[166:167], v[166:167], v[4:5], v[4:5] op_sel:[0,0,1] op_sel_hi:[1,0,1]
    v_pk_mul_f32 v[160:161], v[160:161], v[72:73]
    v_pk_mul_f32 v[162:163], v[162:163], v[74:75]
    v_pk_mul_f32 v[164:165], v[164:165], v[88:89]
    v_pk_mul_f32 v[166:167], v[166:167], v[90:91]
    v_exp_f32 v160, v160
    v_exp_f32 v161, v161
    buffer_store_dwordx4 v[188:191], v240, s[20:23], s71 offen offset:2048
    v_exp_f32 v162, v162
    v_exp_f32 v163, v163
    v_exp_f32 v164, v164
    v_exp_f32 v165, v165
    v_exp_f32 v166, v166
    v_exp_f32 v167, v167
    v_pk_add_f32 v[160:161], v[160:161], 1.0 op_sel_hi:[1,0]
    v_pk_add_f32 v[162:163], v[162:163], 1.0 op_sel_hi:[1,0]
    v_pk_add_f32 v[164:165], v[164:165], 1.0 op_sel_hi:[1,0]
    v_pk_add_f32 v[166:167], v[166:167], 1.0 op_sel_hi:[1,0]
    v_rcp_f32 v160, v160
    v_rcp_f32 v161, v161
    ds_write_b128 v242, v[188:191] offset:34816
    v_rcp_f32 v162, v162
    v_rcp_f32 v163, v163
    v_rcp_f32 v164, v164
    v_rcp_f32 v165, v165
    v_rcp_f32 v166, v166
    v_rcp_f32 v167, v167
    v_pk_mul_f32 v[160:161], v[160:161], v[72:73]
    v_pk_mul_f32 v[162:163], v[162:163], v[74:75]
    v_pk_mul_f32 v[164:165], v[164:165], v[88:89]
    v_pk_mul_f32 v[166:167], v[166:167], v[90:91]
    v_cvt_pk_bf16_f32 v168, v160, v161
    v_cvt_pk_bf16_f32 v169, v162, v163
    v_cvt_pk_bf16_f32 v170, v164, v165
    v_cvt_pk_bf16_f32 v171, v166, v167
    v_pk_mul_f32 v[160:161], v[76:77], v[76:77]
    v_pk_mul_f32 v[162:163], v[78:79], v[78:79]
    v_pk_mul_f32 v[164:165], v[92:93], v[92:93]
    v_pk_mul_f32 v[166:167], v[94:95], v[94:95]
    v_pk_fma_f32 v[160:161], v[160:161], v[4:5], v[4:5] op_sel:[0,0,1] op_sel_hi:[1,0,1]
    v_pk_fma_f32 v[162:163], v[162:163], v[4:5], v[4:5] op_sel:[0,0,1] op_sel_hi:[1,0,1]
    v_pk_fma_f32 v[164:165], v[164:165], v[4:5], v[4:5] op_sel:[0,0,1] op_sel_hi:[1,0,1]
    v_pk_fma_f32 v[166:167], v[166:167], v[4:5], v[4:5] op_sel:[0,0,1] op_sel_hi:[1,0,1]
    v_pk_mul_f32 v[160:161], v[160:161], v[76:77]
    v_pk_mul_f32 v[162:163], v[162:163], v[78:79]
    v_pk_mul_f32 v[164:165], v[164:165], v[92:93]
    v_pk_mul_f32 v[166:167], v[166:167], v[94:95]
    v_exp_f32 v160, v160
    v_exp_f32 v161, v161
    buffer_store_dwordx4 v[168:171], v240, s[20:23], s72 offen offset:2048
    v_exp_f32 v162, v162
    v_exp_f32 v163, v163
    v_exp_f32 v164, v164
    v_exp_f32 v165, v165
    v_exp_f32 v166, v166
    v_exp_f32 v167, v167
    v_pk_add_f32 v[160:161], v[160:161], 1.0 op_sel_hi:[1,0]
    v_pk_add_f32 v[162:163], v[162:163], 1.0 op_sel_hi:[1,0]
    v_pk_add_f32 v[164:165], v[164:165], 1.0 op_sel_hi:[1,0]
    v_pk_add_f32 v[166:167], v[166:167], 1.0 op_sel_hi:[1,0]
    v_rcp_f32 v160, v160
    v_rcp_f32 v161, v161
    ds_write_b128 v243, v[168:171] offset:32768
    v_rcp_f32 v162, v162
    v_rcp_f32 v163, v163
    v_rcp_f32 v164, v164
    v_rcp_f32 v165, v165
    v_rcp_f32 v166, v166
    v_rcp_f32 v167, v167
    v_pk_mul_f32 v[160:161], v[160:161], v[76:77]
    v_pk_mul_f32 v[162:163], v[162:163], v[78:79]
    v_pk_mul_f32 v[164:165], v[164:165], v[92:93]
    v_pk_mul_f32 v[166:167], v[166:167], v[94:95]
    v_cvt_pk_bf16_f32 v172, v160, v161
    v_cvt_pk_bf16_f32 v173, v162, v163
    v_cvt_pk_bf16_f32 v174, v164, v165
    v_cvt_pk_bf16_f32 v175, v166, v167
    v_pk_mul_f32 v[160:161], v[96:97], v[96:97]
    v_pk_mul_f32 v[162:163], v[98:99], v[98:99]
    v_pk_mul_f32 v[164:165], v[112:113], v[112:113]
    v_pk_mul_f32 v[166:167], v[114:115], v[114:115]
    v_pk_fma_f32 v[160:161], v[160:161], v[4:5], v[4:5] op_sel:[0,0,1] op_sel_hi:[1,0,1]
    v_pk_fma_f32 v[162:163], v[162:163], v[4:5], v[4:5] op_sel:[0,0,1] op_sel_hi:[1,0,1]
    v_pk_fma_f32 v[164:165], v[164:165], v[4:5], v[4:5] op_sel:[0,0,1] op_sel_hi:[1,0,1]
    v_pk_fma_f32 v[166:167], v[166:167], v[4:5], v[4:5] op_sel:[0,0,1] op_sel_hi:[1,0,1]
    v_pk_mul_f32 v[160:161], v[160:161], v[96:97]
    v_pk_mul_f32 v[162:163], v[162:163], v[98:99]
    v_pk_mul_f32 v[164:165], v[164:165], v[112:113]
    v_pk_mul_f32 v[166:167], v[166:167], v[114:115]
    v_exp_f32 v160, v160
    v_exp_f32 v161, v161
    buffer_store_dwordx4 v[172:175], v240, s[20:23], s73 offen offset:2048
    v_exp_f32 v162, v162
    v_exp_f32 v163, v163
    v_exp_f32 v164, v164
    v_exp_f32 v165, v165
    v_exp_f32 v166, v166
    v_exp_f32 v167, v167
    v_pk_add_f32 v[160:161], v[160:161], 1.0 op_sel_hi:[1,0]
    v_pk_add_f32 v[162:163], v[162:163], 1.0 op_sel_hi:[1,0]
    v_pk_add_f32 v[164:165], v[164:165], 1.0 op_sel_hi:[1,0]
    v_pk_add_f32 v[166:167], v[166:167], 1.0 op_sel_hi:[1,0]
    v_rcp_f32 v160, v160
    v_rcp_f32 v161, v161
    ds_write_b128 v243, v[172:175] offset:34816
    v_rcp_f32 v162, v162
    v_rcp_f32 v163, v163
    v_rcp_f32 v164, v164
    v_rcp_f32 v165, v165
    v_rcp_f32 v166, v166
    v_rcp_f32 v167, v167
    v_pk_mul_f32 v[160:161], v[160:161], v[96:97]
    v_pk_mul_f32 v[162:163], v[162:163], v[98:99]
    v_pk_mul_f32 v[164:165], v[164:165], v[112:113]
    v_pk_mul_f32 v[166:167], v[166:167], v[114:115]
    v_cvt_pk_bf16_f32 v176, v160, v161
    v_cvt_pk_bf16_f32 v177, v162, v163
    v_cvt_pk_bf16_f32 v178, v164, v165
    v_cvt_pk_bf16_f32 v179, v166, v167
    v_pk_mul_f32 v[160:161], v[100:101], v[100:101]
    v_pk_mul_f32 v[162:163], v[102:103], v[102:103]
    v_pk_mul_f32 v[164:165], v[116:117], v[116:117]
    v_pk_mul_f32 v[166:167], v[118:119], v[118:119]
    v_pk_fma_f32 v[160:161], v[160:161], v[4:5], v[4:5] op_sel:[0,0,1] op_sel_hi:[1,0,1]
    v_pk_fma_f32 v[162:163], v[162:163], v[4:5], v[4:5] op_sel:[0,0,1] op_sel_hi:[1,0,1]
    v_pk_fma_f32 v[164:165], v[164:165], v[4:5], v[4:5] op_sel:[0,0,1] op_sel_hi:[1,0,1]
    v_pk_fma_f32 v[166:167], v[166:167], v[4:5], v[4:5] op_sel:[0,0,1] op_sel_hi:[1,0,1]
    v_pk_mul_f32 v[160:161], v[160:161], v[100:101]
    v_pk_mul_f32 v[162:163], v[162:163], v[102:103]
    v_pk_mul_f32 v[164:165], v[164:165], v[116:117]
    v_pk_mul_f32 v[166:167], v[166:167], v[118:119]
    v_exp_f32 v160, v160
    v_exp_f32 v161, v161
    v_add_u32 v240, 4096, v240
    buffer_store_dwordx4 v[176:179], v240, s[20:23], s70 offen offset:0 sc1
    v_exp_f32 v162, v162
    v_exp_f32 v163, v163
    v_exp_f32 v164, v164
    v_exp_f32 v165, v165
    v_exp_f32 v166, v166
    v_exp_f32 v167, v167
    v_pk_add_f32 v[160:161], v[160:161], 1.0 op_sel_hi:[1,0]
    v_pk_add_f32 v[162:163], v[162:163], 1.0 op_sel_hi:[1,0]
    v_pk_add_f32 v[164:165], v[164:165], 1.0 op_sel_hi:[1,0]
    v_pk_add_f32 v[166:167], v[166:167], 1.0 op_sel_hi:[1,0]
    v_rcp_f32 v160, v160
    v_rcp_f32 v161, v161
    v_add_u32 v242, 65536, v242
    v_add_u32 v243, 65536, v243
    ds_write_b128 v242, v[176:179] offset:0
    v_rcp_f32 v162, v162
    v_rcp_f32 v163, v163
    v_rcp_f32 v164, v164
    v_rcp_f32 v165, v165
    v_rcp_f32 v166, v166
    v_rcp_f32 v167, v167
    v_pk_mul_f32 v[160:161], v[160:161], v[100:101]
    v_pk_mul_f32 v[162:163], v[162:163], v[102:103]
    v_pk_mul_f32 v[164:165], v[164:165], v[116:117]
    v_pk_mul_f32 v[166:167], v[166:167], v[118:119]
    v_cvt_pk_bf16_f32 v180, v160, v161
    v_cvt_pk_bf16_f32 v181, v162, v163
    v_cvt_pk_bf16_f32 v182, v164, v165
    v_cvt_pk_bf16_f32 v183, v166, v167
    v_pk_mul_f32 v[160:161], v[104:105], v[104:105]
    v_pk_mul_f32 v[162:163], v[106:107], v[106:107]
    v_pk_mul_f32 v[164:165], v[120:121], v[120:121]
    v_pk_mul_f32 v[166:167], v[122:123], v[122:123]
    v_pk_fma_f32 v[160:161], v[160:161], v[4:5], v[4:5] op_sel:[0,0,1] op_sel_hi:[1,0,1]
    v_pk_fma_f32 v[162:163], v[162:163], v[4:5], v[4:5] op_sel:[0,0,1] op_sel_hi:[1,0,1]
    v_pk_fma_f32 v[164:165], v[164:165], v[4:5], v[4:5] op_sel:[0,0,1] op_sel_hi:[1,0,1]
    v_pk_fma_f32 v[166:167], v[166:167], v[4:5], v[4:5] op_sel:[0,0,1] op_sel_hi:[1,0,1]
    v_pk_mul_f32 v[160:161], v[160:161], v[104:105]
    v_pk_mul_f32 v[162:163], v[162:163], v[106:107]
    v_pk_mul_f32 v[164:165], v[164:165], v[120:121]
    v_pk_mul_f32 v[166:167], v[166:167], v[122:123]
    v_exp_f32 v160, v160
    v_exp_f32 v161, v161
    buffer_store_dwordx4 v[180:183], v240, s[20:23], s71 offen offset:0 sc1
    v_exp_f32 v162, v162
    v_exp_f32 v163, v163
    v_exp_f32 v164, v164
    v_exp_f32 v165, v165
    v_exp_f32 v166, v166
    v_exp_f32 v167, v167
    v_pk_add_f32 v[160:161], v[160:161], 1.0 op_sel_hi:[1,0]
    v_pk_add_f32 v[162:163], v[162:163], 1.0 op_sel_hi:[1,0]
    v_pk_add_f32 v[164:165], v[164:165], 1.0 op_sel_hi:[1,0]
    v_pk_add_f32 v[166:167], v[166:167], 1.0 op_sel_hi:[1,0]
    v_rcp_f32 v160, v160
    v_rcp_f32 v161, v161
    ds_write_b128 v242, v[180:183] offset:2048
    s_waitcnt vmcnt(2)
    v_mov_b32 v15, s64
    buffer_store_dword v15, v14, s[20:23], 0 offen
    v_rcp_f32 v162, v162
    v_rcp_f32 v163, v163
    v_rcp_f32 v164, v164
    v_rcp_f32 v165, v165
    v_rcp_f32 v166, v166
    v_rcp_f32 v167, v167
    v_pk_mul_f32 v[160:161], v[160:161], v[104:105]
    v_pk_mul_f32 v[162:163], v[162:163], v[106:107]
    v_pk_mul_f32 v[164:165], v[164:165], v[120:121]
    v_pk_mul_f32 v[166:167], v[166:167], v[122:123]
    v_cvt_pk_bf16_f32 v184, v160, v161
    v_cvt_pk_bf16_f32 v185, v162, v163
    v_cvt_pk_bf16_f32 v186, v164, v165
    v_cvt_pk_bf16_f32 v187, v166, v167
    v_pk_mul_f32 v[160:161], v[108:109], v[108:109]
    v_pk_mul_f32 v[162:163], v[110:111], v[110:111]
    v_pk_mul_f32 v[164:165], v[124:125], v[124:125]
    v_pk_mul_f32 v[166:167], v[126:127], v[126:127]
    v_pk_fma_f32 v[160:161], v[160:161], v[4:5], v[4:5] op_sel:[0,0,1] op_sel_hi:[1,0,1]
    v_pk_fma_f32 v[162:163], v[162:163], v[4:5], v[4:5] op_sel:[0,0,1] op_sel_hi:[1,0,1]
    v_pk_fma_f32 v[164:165], v[164:165], v[4:5], v[4:5] op_sel:[0,0,1] op_sel_hi:[1,0,1]
    v_pk_fma_f32 v[166:167], v[166:167], v[4:5], v[4:5] op_sel:[0,0,1] op_sel_hi:[1,0,1]
    v_pk_mul_f32 v[160:161], v[160:161], v[108:109]
    v_pk_mul_f32 v[162:163], v[162:163], v[110:111]
    v_pk_mul_f32 v[164:165], v[164:165], v[124:125]
    v_pk_mul_f32 v[166:167], v[166:167], v[126:127]
    v_exp_f32 v160, v160
    v_exp_f32 v161, v161
    buffer_store_dwordx4 v[184:187], v240, s[20:23], s72 offen offset:0 sc1
    v_exp_f32 v162, v162
    v_exp_f32 v163, v163
    v_exp_f32 v164, v164
    v_exp_f32 v165, v165
    v_exp_f32 v166, v166
    v_exp_f32 v167, v167
    v_pk_add_f32 v[160:161], v[160:161], 1.0 op_sel_hi:[1,0]
    v_pk_add_f32 v[162:163], v[162:163], 1.0 op_sel_hi:[1,0]
    v_pk_add_f32 v[164:165], v[164:165], 1.0 op_sel_hi:[1,0]
    v_pk_add_f32 v[166:167], v[166:167], 1.0 op_sel_hi:[1,0]
    v_rcp_f32 v160, v160
    v_rcp_f32 v161, v161
    ds_write_b128 v243, v[184:187] offset:0
    v_rcp_f32 v162, v162
    v_rcp_f32 v163, v163
    v_rcp_f32 v164, v164
    v_rcp_f32 v165, v165
    v_rcp_f32 v166, v166
    v_rcp_f32 v167, v167
    v_pk_mul_f32 v[160:161], v[160:161], v[108:109]
    v_pk_mul_f32 v[162:163], v[162:163], v[110:111]
    v_pk_mul_f32 v[164:165], v[164:165], v[124:125]
    v_pk_mul_f32 v[166:167], v[166:167], v[126:127]
    v_cvt_pk_bf16_f32 v188, v160, v161
    v_cvt_pk_bf16_f32 v189, v162, v163
    v_cvt_pk_bf16_f32 v190, v164, v165
    v_cvt_pk_bf16_f32 v191, v166, v167
    v_pk_mul_f32 v[160:161], v[128:129], v[128:129]
    v_pk_mul_f32 v[162:163], v[130:131], v[130:131]
    v_pk_mul_f32 v[164:165], v[136:137], v[136:137]
    v_pk_mul_f32 v[166:167], v[138:139], v[138:139]
    v_pk_fma_f32 v[160:161], v[160:161], v[4:5], v[4:5] op_sel:[0,0,1] op_sel_hi:[1,0,1]
    v_pk_fma_f32 v[162:163], v[162:163], v[4:5], v[4:5] op_sel:[0,0,1] op_sel_hi:[1,0,1]
    v_pk_fma_f32 v[164:165], v[164:165], v[4:5], v[4:5] op_sel:[0,0,1] op_sel_hi:[1,0,1]
    v_pk_fma_f32 v[166:167], v[166:167], v[4:5], v[4:5] op_sel:[0,0,1] op_sel_hi:[1,0,1]
    v_pk_mul_f32 v[160:161], v[160:161], v[128:129]
    v_pk_mul_f32 v[162:163], v[162:163], v[130:131]
    v_pk_mul_f32 v[164:165], v[164:165], v[136:137]
    v_pk_mul_f32 v[166:167], v[166:167], v[138:139]
    v_exp_f32 v160, v160
    v_exp_f32 v161, v161
    buffer_store_dwordx4 v[188:191], v240, s[20:23], s73 offen offset:0 sc1
    v_exp_f32 v162, v162
    v_exp_f32 v163, v163
    v_exp_f32 v164, v164
    v_exp_f32 v165, v165
    v_exp_f32 v166, v166
    v_exp_f32 v167, v167
    v_pk_add_f32 v[160:161], v[160:161], 1.0 op_sel_hi:[1,0]
    v_pk_add_f32 v[162:163], v[162:163], 1.0 op_sel_hi:[1,0]
    v_pk_add_f32 v[164:165], v[164:165], 1.0 op_sel_hi:[1,0]
    v_pk_add_f32 v[166:167], v[166:167], 1.0 op_sel_hi:[1,0]
    v_rcp_f32 v160, v160
    v_rcp_f32 v161, v161
    ds_write_b128 v243, v[188:191] offset:2048
    v_rcp_f32 v162, v162
    v_rcp_f32 v163, v163
    v_rcp_f32 v164, v164
    v_rcp_f32 v165, v165
    v_rcp_f32 v166, v166
    v_rcp_f32 v167, v167
    v_pk_mul_f32 v[160:161], v[160:161], v[128:129]
    v_pk_mul_f32 v[162:163], v[162:163], v[130:131]
    v_pk_mul_f32 v[164:165], v[164:165], v[136:137]
    v_pk_mul_f32 v[166:167], v[166:167], v[138:139]
    v_cvt_pk_bf16_f32 v168, v160, v161
    v_cvt_pk_bf16_f32 v169, v162, v163
    v_cvt_pk_bf16_f32 v170, v164, v165
    v_cvt_pk_bf16_f32 v171, v166, v167
    v_pk_mul_f32 v[160:161], v[132:133], v[132:133]
    v_pk_mul_f32 v[162:163], v[134:135], v[134:135]
    v_pk_mul_f32 v[164:165], v[140:141], v[140:141]
    v_pk_mul_f32 v[166:167], v[142:143], v[142:143]
    v_pk_fma_f32 v[160:161], v[160:161], v[4:5], v[4:5] op_sel:[0,0,1] op_sel_hi:[1,0,1]
    v_pk_fma_f32 v[162:163], v[162:163], v[4:5], v[4:5] op_sel:[0,0,1] op_sel_hi:[1,0,1]
    v_pk_fma_f32 v[164:165], v[164:165], v[4:5], v[4:5] op_sel:[0,0,1] op_sel_hi:[1,0,1]
    v_pk_fma_f32 v[166:167], v[166:167], v[4:5], v[4:5] op_sel:[0,0,1] op_sel_hi:[1,0,1]
    v_pk_mul_f32 v[160:161], v[160:161], v[132:133]
    v_pk_mul_f32 v[162:163], v[162:163], v[134:135]
    v_pk_mul_f32 v[164:165], v[164:165], v[140:141]
    v_pk_mul_f32 v[166:167], v[166:167], v[142:143]
    v_exp_f32 v160, v160
    v_exp_f32 v161, v161
    buffer_store_dwordx4 v[168:171], v241, s[20:23], s70 offen sc1
    v_exp_f32 v162, v162
    v_exp_f32 v163, v163
    v_exp_f32 v164, v164
    v_exp_f32 v165, v165
    v_exp_f32 v166, v166
    v_exp_f32 v167, v167
    v_pk_add_f32 v[160:161], v[160:161], 1.0 op_sel_hi:[1,0]
    v_pk_add_f32 v[162:163], v[162:163], 1.0 op_sel_hi:[1,0]
    v_pk_add_f32 v[164:165], v[164:165], 1.0 op_sel_hi:[1,0]
    v_pk_add_f32 v[166:167], v[166:167], 1.0 op_sel_hi:[1,0]
    v_rcp_f32 v160, v160
    v_rcp_f32 v161, v161
    ds_write_b128 v244, v[168:171] offset:0
    v_rcp_f32 v162, v162
    v_rcp_f32 v163, v163
    v_rcp_f32 v164, v164
    v_rcp_f32 v165, v165
    v_rcp_f32 v166, v166
    v_rcp_f32 v167, v167
    v_pk_mul_f32 v[160:161], v[160:161], v[132:133]
    v_pk_mul_f32 v[162:163], v[162:163], v[134:135]
    v_pk_mul_f32 v[164:165], v[164:165], v[140:141]
    v_pk_mul_f32 v[166:167], v[166:167], v[142:143]
    v_cvt_pk_bf16_f32 v172, v160, v161
    v_cvt_pk_bf16_f32 v173, v162, v163
    v_cvt_pk_bf16_f32 v174, v164, v165
    v_cvt_pk_bf16_f32 v175, v166, v167
    ds_write_b128 v244, v[172:175] offset:2048
    buffer_store_dwordx4 v[172:175], v241, s[20:23], s71 offen sc1
    s_mov_b32 s57, 1
    s_mov_b32 s59, 32768
    s_mov_b32 s58, 32768
    s_mov_b32 s61, 2
    s_waitcnt lgkmcnt(0)
    s_barrier
    ds_read_b64_tr_b16 v[96:97], v245 offset:0
    ds_read_b64_tr_b16 v[98:99], v245 offset:2048
    ds_read_b128 v[112:115], v249 offset:0
    ds_read_b128 v[116:119], v249 offset:2048
    ds_read_b128 v[120:123], v250 offset:0
    ds_read_b128 v[124:127], v250 offset:2048
    ds_read_b64_tr_b16 v[100:101], v246 offset:0
    ds_read_b64_tr_b16 v[102:103], v246 offset:2048
    ds_read_b64_tr_b16 v[104:105], v247 offset:0
    ds_read_b64_tr_b16 v[106:107], v247 offset:2048
    ds_read_b64_tr_b16 v[108:109], v248 offset:0
    ds_read_b64_tr_b16 v[110:111], v248 offset:2048
    s_waitcnt lgkmcnt(6)
    v_mfma_f32_16x16x32_bf16 v[32:35], v[96:99], v[112:115], 0
    ds_read_b64_tr_b16 v[128:129], v245 offset:4096
    v_mfma_f32_16x16x32_bf16 v[48:51], v[96:99], v[116:119], 0
    ds_read_b64_tr_b16 v[130:131], v245 offset:6144
    v_mfma_f32_16x16x32_bf16 v[64:67], v[96:99], v[120:123], 0
    ds_read_b128 v[144:147], v249 offset:1024
    v_mfma_f32_16x16x32_bf16 v[80:83], v[96:99], v[124:127], 0
    ds_read_b128 v[148:151], v249 offset:3072
    s_waitcnt lgkmcnt(4)
    v_mfma_f32_16x16x32_bf16 v[36:39], v[100:103], v[112:115], 0
    ds_read_b128 v[152:155], v250 offset:1024
    v_mfma_f32_16x16x32_bf16 v[52:55], v[100:103], v[116:119], 0
    ds_read_b128 v[156:159], v250 offset:3072
    v_mfma_f32_16x16x32_bf16 v[68:71], v[100:103], v[120:123], 0
    ds_read_b64_tr_b16 v[132:133], v246 offset:4096
    v_mfma_f32_16x16x32_bf16 v[84:87], v[100:103], v[124:127], 0
    ds_read_b64_tr_b16 v[134:135], v246 offset:6144
    v_mfma_f32_16x16x32_bf16 v[40:43], v[104:107], v[112:115], 0
    ds_read_b64_tr_b16 v[136:137], v247 offset:4096
    v_mfma_f32_16x16x32_bf16 v[56:59], v[104:107], v[116:119], 0
    ds_read_b64_tr_b16 v[138:139], v247 offset:6144
    v_mfma_f32_16x16x32_bf16 v[72:75], v[104:107], v[120:123], 0
    ds_read_b64_tr_b16 v[140:141], v248 offset:4096
    v_mfma_f32_16x16x32_bf16 v[88:91], v[104:107], v[124:127], 0
    ds_read_b64_tr_b16 v[142:143], v248 offset:6144
    v_mfma_f32_16x16x32_bf16 v[44:47], v[108:111], v[112:115], 0
    v_add_u32 v245, s58, v245
    v_add_u32 v246, s58, v246
    v_mfma_f32_16x16x32_bf16 v[60:63], v[108:111], v[116:119], 0
    v_add_u32 v247, s58, v247
    v_add_u32 v248, s58, v248
    v_mfma_f32_16x16x32_bf16 v[76:79], v[108:111], v[120:123], 0
    v_add_u32 v249, s58, v249
    v_add_u32 v250, s58, v250
    s_waitcnt lgkmcnt(0)
    s_barrier
    v_mfma_f32_16x16x32_bf16 v[92:95], v[108:111], v[124:127], 0
    s_waitcnt lgkmcnt(6)
    v_mfma_f32_16x16x32_bf16 v[32:35], v[128:131], v[144:147], v[32:35]
    ds_read_b64_tr_b16 v[96:97], v245 offset:0
    v_mfma_f32_16x16x32_bf16 v[48:51], v[128:131], v[148:151], v[48:51]
    ds_read_b64_tr_b16 v[98:99], v245 offset:2048
    v_mfma_f32_16x16x32_bf16 v[64:67], v[128:131], v[152:155], v[64:67]
    ds_read_b128 v[112:115], v249 offset:0
    v_mfma_f32_16x16x32_bf16 v[80:83], v[128:131], v[156:159], v[80:83]
    ds_read_b128 v[116:119], v249 offset:2048
    s_waitcnt lgkmcnt(4)
    v_mfma_f32_16x16x32_bf16 v[36:39], v[132:135], v[144:147], v[36:39]
    ds_read_b128 v[120:123], v250 offset:0
    v_mfma_f32_16x16x32_bf16 v[52:55], v[132:135], v[148:151], v[52:55]
    ds_read_b128 v[124:127], v250 offset:2048
    v_mfma_f32_16x16x32_bf16 v[68:71], v[132:135], v[152:155], v[68:71]
    ds_read_b64_tr_b16 v[100:101], v246 offset:0
    v_mfma_f32_16x16x32_bf16 v[84:87], v[132:135], v[156:159], v[84:87]
    ds_read_b64_tr_b16 v[102:103], v246 offset:2048
    v_mfma_f32_16x16x32_bf16 v[40:43], v[136:139], v[144:147], v[40:43]
    ds_read_b64_tr_b16 v[104:105], v247 offset:0
    v_mfma_f32_16x16x32_bf16 v[56:59], v[136:139], v[148:151], v[56:59]
    ds_read_b64_tr_b16 v[106:107], v247 offset:2048
    v_mfma_f32_16x16x32_bf16 v[72:75], v[136:139], v[152:155], v[72:75]
    ds_read_b64_tr_b16 v[108:109], v248 offset:0
    v_mfma_f32_16x16x32_bf16 v[88:91], v[136:139], v[156:159], v[88:91]
    ds_read_b64_tr_b16 v[110:111], v248 offset:2048
    v_mfma_f32_16x16x32_bf16 v[44:47], v[140:143], v[144:147], v[44:47]
    s_add_u32 s57, s57, 1
    s_cmp_eq_u32 s57, 5
    v_mfma_f32_16x16x32_bf16 v[60:63], v[140:143], v[148:151], v[60:63]
    s_cselect_b32 s58, 4294836224, s59
    s_cselect_b32 s57, 0, s57
    v_mfma_f32_16x16x32_bf16 v[76:79], v[140:143], v[152:155], v[76:79]
    v_mfma_f32_16x16x32_bf16 v[92:95], v[140:143], v[156:159], v[92:95]
    s_waitcnt lgkmcnt(6)
    v_mfma_f32_16x16x32_bf16 v[32:35], v[96:99], v[112:115], v[32:35]
    ds_read_b64_tr_b16 v[128:129], v245 offset:4096
    v_mfma_f32_16x16x32_bf16 v[48:51], v[96:99], v[116:119], v[48:51]
    ds_read_b64_tr_b16 v[130:131], v245 offset:6144
    v_mfma_f32_16x16x32_bf16 v[64:67], v[96:99], v[120:123], v[64:67]
    ds_read_b128 v[144:147], v249 offset:1024
    v_mfma_f32_16x16x32_bf16 v[80:83], v[96:99], v[124:127], v[80:83]
    ds_read_b128 v[148:151], v249 offset:3072
    s_waitcnt lgkmcnt(4)
    v_mfma_f32_16x16x32_bf16 v[36:39], v[100:103], v[112:115], v[36:39]
    ds_read_b128 v[152:155], v250 offset:1024
    v_mfma_f32_16x16x32_bf16 v[52:55], v[100:103], v[116:119], v[52:55]
    ds_read_b128 v[156:159], v250 offset:3072
    v_mfma_f32_16x16x32_bf16 v[68:71], v[100:103], v[120:123], v[68:71]
    ds_read_b64_tr_b16 v[132:133], v246 offset:4096
    v_mfma_f32_16x16x32_bf16 v[84:87], v[100:103], v[124:127], v[84:87]
    ds_read_b64_tr_b16 v[134:135], v246 offset:6144
    v_mfma_f32_16x16x32_bf16 v[40:43], v[104:107], v[112:115], v[40:43]
    ds_read_b64_tr_b16 v[136:137], v247 offset:4096
    v_mfma_f32_16x16x32_bf16 v[56:59], v[104:107], v[116:119], v[56:59]
    ds_read_b64_tr_b16 v[138:139], v247 offset:6144
    v_mfma_f32_16x16x32_bf16 v[72:75], v[104:107], v[120:123], v[72:75]
    ds_read_b64_tr_b16 v[140:141], v248 offset:4096
    v_mfma_f32_16x16x32_bf16 v[88:91], v[104:107], v[124:127], v[88:91]
    ds_read_b64_tr_b16 v[142:143], v248 offset:6144
    v_mfma_f32_16x16x32_bf16 v[44:47], v[108:111], v[112:115], v[44:47]
    v_add_u32 v245, s58, v245
    v_add_u32 v246, s58, v246
    v_mfma_f32_16x16x32_bf16 v[60:63], v[108:111], v[116:119], v[60:63]
    v_add_u32 v247, s58, v247
    v_add_u32 v248, s58, v248
    v_mfma_f32_16x16x32_bf16 v[76:79], v[108:111], v[120:123], v[76:79]
    v_add_u32 v249, s58, v249
    v_add_u32 v250, s58, v250
    v_mfma_f32_16x16x32_bf16 v[92:95], v[108:111], v[124:127], v[92:95]
    s_waitcnt lgkmcnt(6)
    v_mfma_f32_16x16x32_bf16 v[32:35], v[128:131], v[144:147], v[32:35]
    ds_read_b64_tr_b16 v[96:97], v245 offset:0
    v_mfma_f32_16x16x32_bf16 v[48:51], v[128:131], v[148:151], v[48:51]
    ds_read_b64_tr_b16 v[98:99], v245 offset:2048
    v_mfma_f32_16x16x32_bf16 v[64:67], v[128:131], v[152:155], v[64:67]
    ds_read_b128 v[112:115], v249 offset:0
    v_mfma_f32_16x16x32_bf16 v[80:83], v[128:131], v[156:159], v[80:83]
    ds_read_b128 v[116:119], v249 offset:2048
    s_waitcnt lgkmcnt(4)
    v_mfma_f32_16x16x32_bf16 v[36:39], v[132:135], v[144:147], v[36:39]
    ds_read_b128 v[120:123], v250 offset:0
    v_mfma_f32_16x16x32_bf16 v[52:55], v[132:135], v[148:151], v[52:55]
    ds_read_b128 v[124:127], v250 offset:2048
    v_mfma_f32_16x16x32_bf16 v[68:71], v[132:135], v[152:155], v[68:71]
    ds_read_b64_tr_b16 v[100:101], v246 offset:0
    v_mfma_f32_16x16x32_bf16 v[84:87], v[132:135], v[156:159], v[84:87]
    ds_read_b64_tr_b16 v[102:103], v246 offset:2048
    v_mfma_f32_16x16x32_bf16 v[40:43], v[136:139], v[144:147], v[40:43]
    ds_read_b64_tr_b16 v[104:105], v247 offset:0
    v_mfma_f32_16x16x32_bf16 v[56:59], v[136:139], v[148:151], v[56:59]
    ds_read_b64_tr_b16 v[106:107], v247 offset:2048
    v_mfma_f32_16x16x32_bf16 v[72:75], v[136:139], v[152:155], v[72:75]
    ds_read_b64_tr_b16 v[108:109], v248 offset:0
    v_mfma_f32_16x16x32_bf16 v[88:91], v[136:139], v[156:159], v[88:91]
    ds_read_b64_tr_b16 v[110:111], v248 offset:2048
    v_mfma_f32_16x16x32_bf16 v[44:47], v[140:143], v[144:147], v[44:47]
    s_add_u32 s57, s57, 1
    s_cmp_eq_u32 s57, 5
    v_mfma_f32_16x16x32_bf16 v[60:63], v[140:143], v[148:151], v[60:63]
    s_cselect_b32 s58, 4294836224, s59
    s_cselect_b32 s57, 0, s57
    v_mfma_f32_16x16x32_bf16 v[76:79], v[140:143], v[152:155], v[76:79]
    v_mfma_f32_16x16x32_bf16 v[92:95], v[140:143], v[156:159], v[92:95]
    s_mov_b32 s62, 6
KM_c2loop:
    s_waitcnt lgkmcnt(6)
    v_mfma_f32_16x16x32_bf16 v[32:35], v[96:99], v[112:115], v[32:35]
    ds_read_b64_tr_b16 v[128:129], v245 offset:4096
    v_mfma_f32_16x16x32_bf16 v[48:51], v[96:99], v[116:119], v[48:51]
    ds_read_b64_tr_b16 v[130:131], v245 offset:6144
    v_mfma_f32_16x16x32_bf16 v[64:67], v[96:99], v[120:123], v[64:67]
    ds_read_b128 v[144:147], v249 offset:1024
    v_mfma_f32_16x16x32_bf16 v[80:83], v[96:99], v[124:127], v[80:83]
    ds_read_b128 v[148:151], v249 offset:3072
    s_waitcnt lgkmcnt(4)
    v_mfma_f32_16x16x32_bf16 v[36:39], v[100:103], v[112:115], v[36:39]
    ds_read_b128 v[152:155], v250 offset:1024
    v_mfma_f32_16x16x32_bf16 v[52:55], v[100:103], v[116:119], v[52:55]
    ds_read_b128 v[156:159], v250 offset:3072
    v_mfma_f32_16x16x32_bf16 v[68:71], v[100:103], v[120:123], v[68:71]
    ds_read_b64_tr_b16 v[132:133], v246 offset:4096
    v_mfma_f32_16x16x32_bf16 v[84:87], v[100:103], v[124:127], v[84:87]
    ds_read_b64_tr_b16 v[134:135], v246 offset:6144
    v_mfma_f32_16x16x32_bf16 v[40:43], v[104:107], v[112:115], v[40:43]
    ds_read_b64_tr_b16 v[136:137], v247 offset:4096
    v_mfma_f32_16x16x32_bf16 v[56:59], v[104:107], v[116:119], v[56:59]
    ds_read_b64_tr_b16 v[138:139], v247 offset:6144
    v_mfma_f32_16x16x32_bf16 v[72:75], v[104:107], v[120:123], v[72:75]
    ds_read_b64_tr_b16 v[140:141], v248 offset:4096
    v_mfma_f32_16x16x32_bf16 v[88:91], v[104:107], v[124:127], v[88:91]
    ds_read_b64_tr_b16 v[142:143], v248 offset:6144
    v_mfma_f32_16x16x32_bf16 v[44:47], v[108:111], v[112:115], v[44:47]
    v_add_u32 v245, s58, v245
    v_add_u32 v246, s58, v246
    v_mfma_f32_16x16x32_bf16 v[60:63], v[108:111], v[116:119], v[60:63]
    v_add_u32 v247, s58, v247
    v_add_u32 v248, s58, v248
    v_mfma_f32_16x16x32_bf16 v[76:79], v[108:111], v[120:123], v[76:79]
    v_add_u32 v249, s58, v249
    v_add_u32 v250, s58, v250
    s_barrier
    v_mfma_f32_16x16x32_bf16 v[92:95], v[108:111], v[124:127], v[92:95]
    s_waitcnt lgkmcnt(6)
    v_mfma_f32_16x16x32_bf16 v[32:35], v[128:131], v[144:147], v[32:35]
    ds_read_b64_tr_b16 v[96:97], v245 offset:0
    v_mfma_f32_16x16x32_bf16 v[48:51], v[128:131], v[148:151], v[48:51]
    ds_read_b64_tr_b16 v[98:99], v245 offset:2048
    v_mfma_f32_16x16x32_bf16 v[64:67], v[128:131], v[152:155], v[64:67]
    ds_read_b128 v[112:115], v249 offset:0
    v_mfma_f32_16x16x32_bf16 v[80:83], v[128:131], v[156:159], v[80:83]
    ds_read_b128 v[116:119], v249 offset:2048
    s_waitcnt lgkmcnt(4)
    v_mfma_f32_16x16x32_bf16 v[36:39], v[132:135], v[144:147], v[36:39]
    ds_read_b128 v[120:123], v250 offset:0
    v_mfma_f32_16x16x32_bf16 v[52:55], v[132:135], v[148:151], v[52:55]
    ds_read_b128 v[124:127], v250 offset:2048
    v_mfma_f32_16x16x32_bf16 v[68:71], v[132:135], v[152:155], v[68:71]
    ds_read_b64_tr_b16 v[100:101], v246 offset:0
    v_mfma_f32_16x16x32_bf16 v[84:87], v[132:135], v[156:159], v[84:87]
    ds_read_b64_tr_b16 v[102:103], v246 offset:2048
    v_mfma_f32_16x16x32_bf16 v[40:43], v[136:139], v[144:147], v[40:43]
    ds_read_b64_tr_b16 v[104:105], v247 offset:0
    v_mfma_f32_16x16x32_bf16 v[56:59], v[136:139], v[148:151], v[56:59]
    ds_read_b64_tr_b16 v[106:107], v247 offset:2048
    v_mfma_f32_16x16x32_bf16 v[72:75], v[136:139], v[152:155], v[72:75]
    ds_read_b64_tr_b16 v[108:109], v248 offset:0
    v_mfma_f32_16x16x32_bf16 v[88:91], v[136:139], v[156:159], v[88:91]
    ds_read_b64_tr_b16 v[110:111], v248 offset:2048
    v_mfma_f32_16x16x32_bf16 v[44:47], v[140:143], v[144:147], v[44:47]
    s_add_u32 s57, s57, 1
    s_cmp_eq_u32 s57, 5
    v_mfma_f32_16x16x32_bf16 v[60:63], v[140:143], v[148:151], v[60:63]
    s_cselect_b32 s58, 4294836224, s59
    s_cselect_b32 s57, 0, s57
    v_mfma_f32_16x16x32_bf16 v[76:79], v[140:143], v[152:155], v[76:79]
    s_add_u32 s61, s61, 1
    s_cmp_lt_u32 s61, s62
    v_mfma_f32_16x16x32_bf16 v[92:95], v[140:143], v[156:159], v[92:95]
    s_cbranch_scc1 KM_c2loop
    s_cmp_eq_u32 s61, 26
    s_cbranch_scc1 KM_c2done
    s_waitcnt vmcnt(0)
    v_mov_b32 v15, s65
    v_mov_b32 v13, 2
    buffer_store_dword v15, v14, s[20:23], 0 offen
    buffer_store_dword v13, v14, s[20:23], s75 offen sc1
    s_mov_b32 s62, 26
    s_branch KM_c2loop
KM_c2done:
    s_waitcnt lgkmcnt(0)
    v_mfma_f32_16x16x32_bf16 v[64:67], v[96:99], v[120:123], v[64:67]
    ds_read_b64_tr_b16 v[128:129], v245 offset:4096
    ds_read_b64_tr_b16 v[130:131], v245 offset:6144
    v_mfma_f32_16x16x32_bf16 v[80:83], v[96:99], v[124:127], v[80:83]
    ds_read_b128 v[152:155], v250 offset:1024
    ds_read_b128 v[156:159], v250 offset:3072
    v_mfma_f32_16x16x32_bf16 v[68:71], v[100:103], v[120:123], v[68:71]
    ds_read_b64_tr_b16 v[132:133], v246 offset:4096
    ds_read_b64_tr_b16 v[134:135], v246 offset:6144
    v_mfma_f32_16x16x32_bf16 v[84:87], v[100:103], v[124:127], v[84:87]
    ds_read_b64_tr_b16 v[136:137], v247 offset:4096
    ds_read_b64_tr_b16 v[138:139], v247 offset:6144
    v_mfma_f32_16x16x32_bf16 v[72:75], v[104:107], v[120:123], v[72:75]
    ds_read_b64_tr_b16 v[140:141], v248 offset:4096
    ds_read_b64_tr_b16 v[142:143], v248 offset:6144
    v_mfma_f32_16x16x32_bf16 v[88:91], v[104:107], v[124:127], v[88:91]
    ds_read_b128 v[144:147], v249 offset:1024
    v_mfma_f32_16x16x32_bf16 v[76:79], v[108:111], v[120:123], v[76:79]
    ds_read_b128 v[148:151], v249 offset:3072
    v_add_u32 v245, s58, v245
    v_add_u32 v246, s58, v246
    v_add_u32 v247, s58, v247
    v_add_u32 v248, s58, v248
    v_add_u32 v249, s58, v249
    v_add_u32 v250, s58, v250
    s_barrier
    v_mfma_f32_16x16x32_bf16 v[92:95], v[108:111], v[124:127], v[92:95]
    s_waitcnt lgkmcnt(8)
    v_mfma_f32_16x16x32_bf16 v[64:67], v[128:131], v[152:155], v[64:67]
    ds_read_b64_tr_b16 v[160:161], v245 offset:0
    ds_read_b64_tr_b16 v[162:163], v245 offset:2048
    v_mfma_f32_16x16x32_bf16 v[80:83], v[128:131], v[156:159], v[80:83]
    ds_read_b128 v[120:123], v250 offset:0
    s_waitcnt lgkmcnt(3)
    v_mfma_f32_16x16x32_bf16 v[68:71], v[132:135], v[152:155], v[68:71]
    ds_read_b128 v[124:127], v250 offset:2048
    ds_read_b64_tr_b16 v[164:165], v246 offset:0
    v_mfma_f32_16x16x32_bf16 v[84:87], v[132:135], v[156:159], v[84:87]
    ds_read_b64_tr_b16 v[166:167], v246 offset:2048
    ds_read_b64_tr_b16 v[168:169], v247 offset:0
    v_mfma_f32_16x16x32_bf16 v[72:75], v[136:139], v[152:155], v[72:75]
    ds_read_b64_tr_b16 v[170:171], v247 offset:2048
    v_mfma_f32_16x16x32_bf16 v[88:91], v[136:139], v[156:159], v[88:91]
    ds_read_b64_tr_b16 v[172:173], v248 offset:0
    v_mfma_f32_16x16x32_bf16 v[76:79], v[140:143], v[152:155], v[76:79]
    ds_read_b64_tr_b16 v[174:175], v248 offset:2048
    v_mfma_f32_16x16x32_bf16 v[92:95], v[140:143], v[156:159], v[92:95]
    buffer_load_dwordx4 v[192:195], v251, s[20:23], s66 offen offset:0 sc1
    s_waitcnt lgkmcnt(6)
    v_mfma_f32_16x16x32_bf16 v[64:67], v[160:163], v[120:123], v[64:67]
    ds_read_b64_tr_b16 v[176:177], v245 offset:4096
    ds_read_b64_tr_b16 v[178:179], v245 offset:6144
    v_mfma_f32_16x16x32_bf16 v[80:83], v[160:163], v[124:127], v[80:83]
    ds_read_b128 v[152:155], v250 offset:1024
    s_waitcnt lgkmcnt(3)
    v_mfma_f32_16x16x32_bf16 v[68:71], v[164:167], v[120:123], v[68:71]
    ds_read_b128 v[156:159], v250 offset:3072
    ds_read_b64_tr_b16 v[180:181], v246 offset:4096
    v_mfma_f32_16x16x32_bf16 v[84:87], v[164:167], v[124:127], v[84:87]
    ds_read_b64_tr_b16 v[182:183], v246 offset:6144
    ds_read_b64_tr_b16 v[184:185], v247 offset:4096
    v_mfma_f32_16x16x32_bf16 v[72:75], v[168:171], v[120:123], v[72:75]
    ds_read_b64_tr_b16 v[186:187], v247 offset:6144
    v_mfma_f32_16x16x32_bf16 v[88:91], v[168:171], v[124:127], v[88:91]
    ds_read_b64_tr_b16 v[188:189], v248 offset:4096
    v_mfma_f32_16x16x32_bf16 v[76:79], v[172:175], v[120:123], v[76:79]
    ds_read_b64_tr_b16 v[190:191], v248 offset:6144
    v_mfma_f32_16x16x32_bf16 v[92:95], v[172:175], v[124:127], v[92:95]
    buffer_load_dwordx4 v[196:199], v251, s[20:23], s66 offen offset:64 sc1
    s_waitcnt lgkmcnt(6)
    v_mfma_f32_16x16x32_bf16 v[64:67], v[176:179], v[152:155], v[64:67]
    ds_read_b128 v[120:123], v249 offset:0
    v_mfma_f32_16x16x32_bf16 v[80:83], v[176:179], v[156:159], v[80:83]
    ds_read_b128 v[124:127], v249 offset:2048
    s_waitcnt lgkmcnt(2)
    v_mfma_f32_16x16x32_bf16 v[68:71], v[180:183], v[152:155], v[68:71]
    buffer_load_dwordx4 v[232:235], v251, s[20:23], s67 offen offset:0 sc1
    v_mfma_f32_16x16x32_bf16 v[84:87], v[180:183], v[156:159], v[84:87]
    buffer_load_dwordx4 v[236:239], v251, s[20:23], s67 offen offset:64 sc1
    v_mfma_f32_16x16x32_bf16 v[72:75], v[184:187], v[152:155], v[72:75]
    buffer_load_dwordx4 v[200:203], v255, s[20:23], 0 offen offset:0
    v_mfma_f32_16x16x32_bf16 v[88:91], v[184:187], v[156:159], v[88:91]
    buffer_load_dwordx4 v[204:207], v255, s[20:23], 0 offen offset:1024
    v_mfma_f32_16x16x32_bf16 v[76:79], v[188:191], v[152:155], v[76:79]
    buffer_load_dwordx4 v[208:211], v255, s[20:23], 0 offen offset:64
    v_mfma_f32_16x16x32_bf16 v[92:95], v[188:191], v[156:159], v[92:95]
    buffer_load_dwordx4 v[212:215], v255, s[20:23], 0 offen offset:1088
    v_mfma_f32_16x16x32_bf16 v[32:35], v[96:99], v[112:115], v[32:35]
    ds_read_b128 v[152:155], v249 offset:1024
    v_mfma_f32_16x16x32_bf16 v[48:51], v[96:99], v[116:119], v[48:51]
    ds_read_b128 v[156:159], v249 offset:3072
    v_mfma_f32_16x16x32_bf16 v[36:39], v[100:103], v[112:115], v[36:39]
    v_cvt_pk_bf16_f32 v216, v64, v65
    v_cvt_pk_bf16_f32 v217, v66, v67
    v_cvt_pk_bf16_f32 v218, v68, v69
    v_cvt_pk_bf16_f32 v219, v70, v71
    v_mfma_f32_16x16x32_bf16 v[52:55], v[100:103], v[116:119], v[52:55]
    v_cvt_pk_bf16_f32 v224, v80, v81
    v_cvt_pk_bf16_f32 v225, v82, v83
    v_cvt_pk_bf16_f32 v226, v84, v85
    v_cvt_pk_bf16_f32 v227, v86, v87
    v_mfma_f32_16x16x32_bf16 v[40:43], v[104:107], v[112:115], v[40:43]
    v_permlane16_swap_b32 v216, v218
    v_permlane16_swap_b32 v217, v219
    buffer_store_dwordx4 v[216:219], v253, s[20:23], 0 offen offset:0 sc1
    v_cvt_pk_bf16_f32 v220, v72, v73
    v_mfma_f32_16x16x32_bf16 v[56:59], v[104:107], v[116:119], v[56:59]
    v_cvt_pk_bf16_f32 v221, v74, v75
    v_cvt_pk_bf16_f32 v222, v76, v77
    v_cvt_pk_bf16_f32 v223, v78, v79
    v_permlane16_swap_b32 v224, v226
    v_mfma_f32_16x16x32_bf16 v[44:47], v[108:111], v[112:115], v[44:47]
    v_permlane16_swap_b32 v225, v227
    buffer_store_dwordx4 v[224:227], v253, s[20:23], 0 offen offset:2048 sc1
    v_cvt_pk_bf16_f32 v228, v88, v89
    v_cvt_pk_bf16_f32 v229, v90, v91
    v_mfma_f32_16x16x32_bf16 v[60:63], v[108:111], v[116:119], v[60:63]
    v_cvt_pk_bf16_f32 v230, v92, v93
    v_cvt_pk_bf16_f32 v231, v94, v95
    v_permlane16_swap_b32 v220, v222
    v_permlane16_swap_b32 v221, v223
    v_mfma_f32_16x16x32_bf16 v[32:35], v[128:131], v[144:147], v[32:35]
    buffer_store_dwordx4 v[220:223], v253, s[20:23], 0 offen offset:1024 sc1
    v_permlane16_swap_b32 v228, v230
    v_permlane16_swap_b32 v229, v231
    buffer_store_dwordx4 v[228:231], v253, s[20:23], 0 offen offset:3072 sc1
    v_mfma_f32_16x16x32_bf16 v[48:51], v[128:131], v[148:151], v[48:51]
    v_mfma_f32_16x16x32_bf16 v[36:39], v[132:135], v[144:147], v[36:39]
    v_mfma_f32_16x16x32_bf16 v[52:55], v[132:135], v[148:151], v[52:55]
    v_mfma_f32_16x16x32_bf16 v[40:43], v[136:139], v[144:147], v[40:43]
    v_mfma_f32_16x16x32_bf16 v[56:59], v[136:139], v[148:151], v[56:59]
    v_mfma_f32_16x16x32_bf16 v[44:47], v[140:143], v[144:147], v[44:47]
    v_mfma_f32_16x16x32_bf16 v[60:63], v[140:143], v[148:151], v[60:63]
    s_waitcnt lgkmcnt(0)
    v_mfma_f32_16x16x32_bf16 v[32:35], v[160:163], v[120:123], v[32:35]
    v_mfma_f32_16x16x32_bf16 v[48:51], v[160:163], v[124:127], v[48:51]
    v_mfma_f32_16x16x32_bf16 v[36:39], v[164:167], v[120:123], v[36:39]
    v_mfma_f32_16x16x32_bf16 v[52:55], v[164:167], v[124:127], v[52:55]
    v_mfma_f32_16x16x32_bf16 v[40:43], v[168:171], v[120:123], v[40:43]
    v_mfma_f32_16x16x32_bf16 v[56:59], v[168:171], v[124:127], v[56:59]
    v_mfma_f32_16x16x32_bf16 v[44:47], v[172:175], v[120:123], v[44:47]
    v_mfma_f32_16x16x32_bf16 v[60:63], v[172:175], v[124:127], v[60:63]
    v_mfma_f32_16x16x32_bf16 v[32:35], v[176:179], v[152:155], v[32:35]
    v_mfma_f32_16x16x32_bf16 v[48:51], v[176:179], v[156:159], v[48:51]
    v_mfma_f32_16x16x32_bf16 v[36:39], v[180:183], v[152:155], v[36:39]
    v_mfma_f32_16x16x32_bf16 v[52:55], v[180:183], v[156:159], v[52:55]
    v_mfma_f32_16x16x32_bf16 v[40:43], v[184:187], v[152:155], v[40:43]
    v_mfma_f32_16x16x32_bf16 v[56:59], v[184:187], v[156:159], v[56:59]
    v_mfma_f32_16x16x32_bf16 v[44:47], v[188:191], v[152:155], v[44:47]
    v_mfma_f32_16x16x32_bf16 v[60:63], v[188:191], v[156:159], v[60:63]
    buffer_load_dwordx4 v[144:147], v254, s[20:23], 0 offen offset:0 sc1
    buffer_load_dwordx4 v[148:151], v254, s[20:23], 0 offen offset:1024 sc1
    buffer_load_dwordx4 v[152:155], v254, s[20:23], 0 offen offset:2048 sc1
    buffer_load_dwordx4 v[156:159], v254, s[20:23], 0 offen offset:3072 sc1
    s_nop 3
    v_permlane16_swap_b32 v32, v36
    v_permlane16_swap_b32 v33, v37
    v_permlane16_swap_b32 v34, v38
    v_permlane16_swap_b32 v35, v39
    v_permlane16_swap_b32 v40, v44
    v_permlane16_swap_b32 v41, v45
    v_permlane16_swap_b32 v42, v46
    v_permlane16_swap_b32 v43, v47
    v_permlane16_swap_b32 v48, v52
    v_permlane16_swap_b32 v49, v53
    v_permlane16_swap_b32 v50, v54
    v_permlane16_swap_b32 v51, v55
    v_permlane16_swap_b32 v56, v60
    v_permlane16_swap_b32 v57, v61
    v_permlane16_swap_b32 v58, v62
    v_permlane16_swap_b32 v59, v63
    s_waitcnt vmcnt(8)
    v_lshlrev_b32 v64, 16, v24
    v_and_b32 v65, 0xffff0000, v24
    v_lshlrev_b32 v66, 16, v25
    v_and_b32 v67, 0xffff0000, v25
    v_lshlrev_b32 v68, 16, v26
    v_and_b32 v69, 0xffff0000, v26
    v_lshlrev_b32 v70, 16, v27
    v_and_b32 v71, 0xffff0000, v27
    v_lshlrev_b32 v72, 16, v28
    v_and_b32 v73, 0xffff0000, v28
    v_lshlrev_b32 v74, 16, v29
    v_and_b32 v75, 0xffff0000, v29
    v_lshlrev_b32 v76, 16, v30
    v_and_b32 v77, 0xffff0000, v30
    v_lshlrev_b32 v78, 16, v31
    v_and_b32 v79, 0xffff0000, v31
    v_lshlrev_b32 v160, 16, v192
    v_and_b32 v161, 0xffff0000, v192
    v_lshlrev_b32 v162, 16, v193
    v_and_b32 v163, 0xffff0000, v193
    v_lshlrev_b32 v164, 16, v194
    v_and_b32 v165, 0xffff0000, v194
    v_lshlrev_b32 v166, 16, v195
    v_and_b32 v167, 0xffff0000, v195
    v_lshlrev_b32 v168, 16, v196
    v_and_b32 v169, 0xffff0000, v196
    v_lshlrev_b32 v170, 16, v197
    v_and_b32 v171, 0xffff0000, v197
    v_lshlrev_b32 v172, 16, v198
    v_and_b32 v173, 0xffff0000, v198
    v_lshlrev_b32 v174, 16, v199
    v_and_b32 v175, 0xffff0000, v199
    v_lshlrev_b32 v176, 16, v232
    v_and_b32 v177, 0xffff0000, v232
    v_lshlrev_b32 v178, 16, v233
    v_and_b32 v179, 0xffff0000, v233
    v_lshlrev_b32 v180, 16, v234
    v_and_b32 v181, 0xffff0000, v234
    v_lshlrev_b32 v182, 16, v235
    v_and_b32 v183, 0xffff0000, v235
    v_lshlrev_b32 v184, 16, v236
    v_and_b32 v185, 0xffff0000, v236
    v_lshlrev_b32 v186, 16, v237
    v_and_b32 v187, 0xffff0000, v237
    v_lshlrev_b32 v188, 16, v238
    v_and_b32 v189, 0xffff0000, v238
    v_lshlrev_b32 v190, 16, v239
    v_and_b32 v191, 0xffff0000, v239
    v_pk_add_f32 v[32:33], v[32:33], v[64:65]
    v_pk_add_f32 v[34:35], v[34:35], v[66:67]
    v_pk_add_f32 v[36:37], v[36:37], v[68:69]
    v_pk_add_f32 v[38:39], v[38:39], v[70:71]
    v_pk_add_f32 v[40:41], v[40:41], v[72:73]
    v_pk_add_f32 v[42:43], v[42:43], v[74:75]
    v_pk_add_f32 v[44:45], v[44:45], v[76:77]
    v_pk_add_f32 v[46:47], v[46:47], v[78:79]
    v_pk_fma_f32 v[160:161], v[32:33], v[200:201], v[160:161]
    v_pk_fma_f32 v[162:163], v[34:35], v[202:203], v[162:163]
    v_pk_fma_f32 v[164:165], v[36:37], v[204:205], v[164:165]
    v_pk_fma_f32 v[166:167], v[38:39], v[206:207], v[166:167]
    v_pk_fma_f32 v[168:169], v[40:41], v[208:209], v[168:169]
    v_pk_fma_f32 v[170:171], v[42:43], v[210:211], v[170:171]
    v_pk_fma_f32 v[172:173], v[44:45], v[212:213], v[172:173]
    v_pk_fma_f32 v[174:175], v[46:47], v[214:215], v[174:175]
    v_pk_add_f32 v[48:49], v[48:49], v[64:65]
    v_pk_add_f32 v[50:51], v[50:51], v[66:67]
    v_pk_add_f32 v[52:53], v[52:53], v[68:69]
    v_pk_add_f32 v[54:55], v[54:55], v[70:71]
    v_pk_add_f32 v[56:57], v[56:57], v[72:73]
    v_pk_add_f32 v[58:59], v[58:59], v[74:75]
    v_pk_add_f32 v[60:61], v[60:61], v[76:77]
    v_pk_add_f32 v[62:63], v[62:63], v[78:79]
    v_pk_fma_f32 v[176:177], v[48:49], v[200:201], v[176:177]
    v_pk_fma_f32 v[178:179], v[50:51], v[202:203], v[178:179]
    v_pk_fma_f32 v[180:181], v[52:53], v[204:205], v[180:181]
    v_pk_fma_f32 v[182:183], v[54:55], v[206:207], v[182:183]
    v_pk_fma_f32 v[184:185], v[56:57], v[208:209], v[184:185]
    v_pk_fma_f32 v[186:187], v[58:59], v[210:211], v[186:187]
    v_pk_fma_f32 v[188:189], v[60:61], v[212:213], v[188:189]
    v_pk_fma_f32 v[190:191], v[62:63], v[214:215], v[190:191]
    s_mov_b32 s72, 0
KM_xpoll:
    s_waitcnt vmcnt(0)
    v_max3_u32 v8, v144, v145, v146
    v_max3_u32 v9, v147, v148, v149
    v_max3_u32 v10, v150, v151, v152
    v_max3_u32 v11, v153, v154, v155
    v_max3_u32 v8, v8, v156, v157
    v_max3_u32 v9, v9, v158, v159
    v_max3_u32 v8, v8, v9, v10
    v_max_u32 v8, v8, v11
    v_cmp_eq_u32 vcc, -1, v8
    s_cbranch_vccz KM_xpoll_x
    s_add_u32 s72, s72, 1
    s_cmp_gt_u32 s72, 65536
    s_cbranch_scc1 KM_xpoll_x
    buffer_load_dwordx4 v[144:147], v254, s[20:23], 0 offen offset:0 sc1
    buffer_load_dwordx4 v[148:151], v254, s[20:23], 0 offen offset:1024 sc1
    buffer_load_dwordx4 v[152:155], v254, s[20:23], 0 offen offset:2048 sc1
    buffer_load_dwordx4 v[156:159], v254, s[20:23], 0 offen offset:3072 sc1
    s_branch KM_xpoll
KM_xpoll_x:
    v_lshlrev_b32 v64, 16, v144
    v_and_b32 v65, 0xffff0000, v144
    v_lshlrev_b32 v66, 16, v145
    v_and_b32 v67, 0xffff0000, v145
    v_lshlrev_b32 v68, 16, v146
    v_and_b32 v69, 0xffff0000, v146
    v_lshlrev_b32 v70, 16, v147
    v_and_b32 v71, 0xffff0000, v147
    v_pk_fma_f32 v[64:65], v[64:65], v[200:201], v[160:161]
    v_pk_fma_f32 v[66:67], v[66:67], v[202:203], v[162:163]
    v_pk_fma_f32 v[68:69], v[68:69], v[204:205], v[164:165]
    v_pk_fma_f32 v[70:71], v[70:71], v[206:207], v[166:167]
    v_cvt_pk_bf16_f32 v112, v64, v65
    v_cvt_pk_bf16_f32 v113, v66, v67
    v_cvt_pk_bf16_f32 v114, v68, v69
    v_cvt_pk_bf16_f32 v115, v70, v71
    buffer_store_dwordx4 v[112:115], v251, s[36:39], 0 offen offset:0
    v_lshlrev_b32 v72, 16, v148
    v_and_b32 v73, 0xffff0000, v148
    v_lshlrev_b32 v74, 16, v149
    v_and_b32 v75, 0xffff0000, v149
    v_lshlrev_b32 v76, 16, v150
    v_and_b32 v77, 0xffff0000, v150
    v_lshlrev_b32 v78, 16, v151
    v_and_b32 v79, 0xffff0000, v151
    v_pk_fma_f32 v[72:73], v[72:73], v[208:209], v[168:169]
    v_pk_fma_f32 v[74:75], v[74:75], v[210:211], v[170:171]
    v_pk_fma_f32 v[76:77], v[76:77], v[212:213], v[172:173]
    v_pk_fma_f32 v[78:79], v[78:79], v[214:215], v[174:175]
    v_cvt_pk_bf16_f32 v116, v72, v73
    v_cvt_pk_bf16_f32 v117, v74, v75
    v_cvt_pk_bf16_f32 v118, v76, v77
    v_cvt_pk_bf16_f32 v119, v78, v79
    buffer_store_dwordx4 v[116:119], v251, s[36:39], 0 offen offset:64
    v_lshlrev_b32 v64, 16, v152
    v_and_b32 v65, 0xffff0000, v152
    v_lshlrev_b32 v66, 16, v153
    v_and_b32 v67, 0xffff0000, v153
    v_lshlrev_b32 v68, 16, v154
    v_and_b32 v69, 0xffff0000, v154
    v_lshlrev_b32 v70, 16, v155
    v_and_b32 v71, 0xffff0000, v155
    v_pk_fma_f32 v[64:65], v[64:65], v[200:201], v[176:177]
    v_pk_fma_f32 v[66:67], v[66:67], v[202:203], v[178:179]
    v_pk_fma_f32 v[68:69], v[68:69], v[204:205], v[180:181]
    v_pk_fma_f32 v[70:71], v[70:71], v[206:207], v[182:183]
    v_cvt_pk_bf16_f32 v120, v64, v65
    v_cvt_pk_bf16_f32 v121, v66, v67
    v_cvt_pk_bf16_f32 v122, v68, v69
    v_cvt_pk_bf16_f32 v123, v70, v71
    buffer_store_dwordx4 v[120:123], v251, s[36:39], s74 offen offset:0
    v_lshlrev_b32 v72, 16, v156
    v_and_b32 v73, 0xffff0000, v156
    v_lshlrev_b32 v74, 16, v157
    v_and_b32 v75, 0xffff0000, v157
    v_lshlrev_b32 v76, 16, v158
    v_and_b32 v77, 0xffff0000, v158
    v_lshlrev_b32 v78, 16, v159
    v_and_b32 v79, 0xffff0000, v159
    v_pk_fma_f32 v[72:73], v[72:73], v[208:209], v[184:185]
    v_pk_fma_f32 v[74:75], v[74:75], v[210:211], v[186:187]
    v_pk_fma_f32 v[76:77], v[76:77], v[212:213], v[188:189]
    v_pk_fma_f32 v[78:79], v[78:79], v[214:215], v[190:191]
    v_cvt_pk_bf16_f32 v124, v72, v73
    v_cvt_pk_bf16_f32 v125, v74, v75
    v_cvt_pk_bf16_f32 v126, v76, v77
    v_cvt_pk_bf16_f32 v127, v78, v79
    buffer_store_dwordx4 v[124:127], v251, s[36:39], s74 offen offset:64
KM_end:
    s_endpgm

.fill 128, 4, 0xbf800000
.section .rodata,"a"
.p2align 6
.amdhsa_kernel ka_kernel
  .amdhsa_next_free_vgpr 224
  .amdhsa_next_free_sgpr 72
  .amdhsa_accum_offset 224
  .amdhsa_group_segment_fixed_size 0
  .amdhsa_kernarg_size 128
  .amdhsa_user_sgpr_count 2
  .amdhsa_user_sgpr_kernarg_segment_ptr 1
  .amdhsa_system_sgpr_workgroup_id_x 1
  .amdhsa_float_denorm_mode_32 3
.end_amdhsa_kernel

.p2align 6
.amdhsa_kernel km_kernel
  .amdhsa_next_free_vgpr 256
  .amdhsa_next_free_sgpr 76
  .amdhsa_accum_offset 256
  .amdhsa_group_segment_fixed_size 0
  .amdhsa_kernarg_size 128
  .amdhsa_user_sgpr_count 2
  .amdhsa_user_sgpr_kernarg_segment_ptr 1
  .amdhsa_system_sgpr_workgroup_id_x 1
  .amdhsa_float_denorm_mode_32 3
.end_amdhsa_kernel
```
